```python
import torch

def _softmax(x, axis=-1):
    return torch.softmax(x, dim=axis)
def _gelu(x):
    return torch.nn.functional.gelu(x, approximate="tanh")
def _silu(x):
    return torch.nn.functional.silu(x)
def _sigmoid(x):
    return torch.sigmoid(x)
def _layernorm(x, axis=-1, eps=1e-5):
    m = x.mean(dim=axis, keepdim=True)
    v = x.var(dim=axis, keepdim=True, unbiased=False)
    return (x - m) / torch.sqrt(v + eps)
def _scatter_add(tgt, idx, src, axis=0):
    return tgt.clone().index_add_(axis, idx, src)
def _segment_sum(src, seg, n):
    out = torch.zeros((n,) + src.shape[1:], dtype=src.dtype)
    return out.index_add_(0, seg, src)
def _pad(x, pw):
    flat = tuple(v for pair in reversed(pw) for v in pair)
    return torch.nn.functional.pad(x, flat)

kernel_name = 'concat_heads__gqa_block_cached__mha_block_cached__decode'

def setup_inputs():

    _w = (lambda a: (lambda t: t.to(torch.bfloat16) if t.is_floating_point() else t)(torch.as_tensor(a)))
    def _A_setup():
        B, Sq, D = 1, 1, 448
        Hq, Hkv, Sk, Dh = 16, 8, 32768, 256
        assert Hq % Hkv == 0, (Hq, Hkv)
        return {
            "x": _w((lambda *s: torch.randn(*s, dtype=torch.bfloat16) * 0.8)(B, Sq, D)),
            "k_cache": _w((lambda *s: torch.randn(*s, dtype=torch.bfloat16) * 1.6)(B, Hkv, Sk, Dh)),
            "v_cache": _w((lambda *s: torch.randn(*s, dtype=torch.bfloat16) * 0.2)(B, Hkv, Sk, Dh)),
            "wq": _w((lambda *s: torch.randn(*s, dtype=torch.bfloat16) * 1.6)(D, Hq * Dh) * (D ** -0.5)),
            "wo": _w((lambda *s: torch.randn(*s, dtype=torch.bfloat16) * 0.2)(Hq * Dh, D) * ((Hq * Dh) ** -0.5)),
        }
    _A_in = _A_setup()

    def _B_setup():
        B, Sq, D = 1, 1, 448
        H, Sk, Dh = 16, 32768, 256
        return {
            "x": _w((lambda *s: torch.randn(*s, dtype=torch.bfloat16) * 0.8)(B, Sq, D)),
            "k_cache": _w((lambda *s: torch.randn(*s, dtype=torch.bfloat16) * 1.6)(B, H, Sk, Dh)),
            "v_cache": _w((lambda *s: torch.randn(*s, dtype=torch.bfloat16) * 0.2)(B, H, Sk, Dh)),
            "wq": _w((lambda *s: torch.randn(*s, dtype=torch.bfloat16) * 1.6)(D, H * Dh) * (D ** -0.5)),
            "wo": _w((lambda *s: torch.randn(*s, dtype=torch.bfloat16) * 0.2)(H * Dh, D) * ((H * Dh) ** -0.5)),
        }
    _B_in = _B_setup()

    return {
        "A_x": _A_in["x"],
        "A_k_cache": _A_in["k_cache"],
        "A_v_cache": _A_in["v_cache"],
        "A_wq": _A_in["wq"],
        "A_wo": _A_in["wo"],
        "B_x": _B_in["x"],
        "B_k_cache": _B_in["k_cache"],
        "B_v_cache": _B_in["v_cache"],
        "B_wq": _B_in["wq"],
        "B_wo": _B_in["wo"],
    }

def reference(A_x, A_k_cache, A_v_cache, A_wq, A_wo, B_x, B_k_cache, B_v_cache, B_wq, B_wo):
    def _A_ref(x, k_cache, v_cache, wq, wo):
        B, Sq, D = x.shape
        Hq, Dh = 16, 256
        Hkv = k_cache.shape[1]
        rep = Hq // Hkv
        q = (lambda x, *d: x.permute(*d))((x @ wq).reshape(B, Sq, Hq, Dh), 0, 2, 1, 3)
        k = (lambda x, n, axis: torch.repeat_interleave(x, n, dim=axis))(k_cache, rep, axis=1)
        v = (lambda x, n, axis: torch.repeat_interleave(x, n, dim=axis))(v_cache, rep, axis=1)
        scores = torch.einsum("bhqd,bhkd->bhqk", q, k) * (Dh ** -0.5)
        p = _softmax(scores, axis=-1)
        o = torch.einsum("bhqk,bhkd->bhqd", p, v)
        return (lambda x, *d: x.permute(*d))(o, 0, 2, 1, 3).reshape(B, Sq, Hq * Dh) @ wo

    def _B_ref(x, k_cache, v_cache, wq, wo):
        B, Sq, D = x.shape
        H, Dh = 16, 256
        q = (lambda x, *d: x.permute(*d))((x @ wq).reshape(B, Sq, H, Dh), 0, 2, 1, 3)
        scores = torch.einsum("bhqd,bhkd->bhqk", q, k_cache) * (Dh ** -0.5)
        p = _softmax(scores, axis=-1)
        o = torch.einsum("bhqk,bhkd->bhqd", p, v_cache)
        return (lambda x, *d: x.permute(*d))(o, 0, 2, 1, 3).reshape(B, Sq, H * Dh) @ wo

    a = _A_ref(A_x, A_k_cache, A_v_cache, A_wq, A_wo)
    b = _B_ref(B_x, B_k_cache, B_v_cache, B_wq, B_wo)
    return torch.concatenate([a, b], axis=-1)
```

```asm
; @launch grid=(256,1,1) block=(192,1,1) lds=75520
.amdgcn_target "amdgcn-amd-amdhsa--gfx950"
.text
.globl concat_heads__gqa_block_cached__mha_block_cached__decode_kernel
.p2align 8
.type concat_heads__gqa_block_cached__mha_block_cached__decode_kernel,@function
concat_heads__gqa_block_cached__mha_block_cached__decode_kernel:
    s_cmp_ge_u32 s2, 256
    s_cbranch_scc1 L_done
    s_load_dwordx16 s[4:19], s[0:1], 0
    s_load_dwordx8 s[20:27], s[0:1], 64
    s_load_dwordx2 s[28:29], s[0:1], 96
    v_lshrrev_b32 v1, 6, v0
    v_and_b32 v0, 63, v0
    v_readfirstlane_b32 s30, v1
    v_and_b32 v2, 15, v0
    v_lshrrev_b32 v3, 4, v0
    s_mov_b32 s38, 2097152
    s_mov_b32 s39, 0x20000
    s_lshr_b32 s48, s2, 4
    s_lshl_b32 s48, s48, 3
    s_and_b32 s49, s2, 7
    s_or_b32 s48, s48, s49
    s_bfe_u32 s55, s2, 0x10003
    s_lshr_b32 s96, s2, 4
    s_lshr_b32 s97, s2, 5
    s_xor_b32 s97, s97, s49
    s_cmp_eq_u32 s30, 0
    s_cbranch_scc0 L_stream
    s_setprio 3
    s_memrealtime s[92:93]
    s_mov_b32 s42, 896
    s_mov_b32 s43, 0x20000
    s_mov_b32 s47, 0x20000
    s_mov_b32 s82, 256
    s_mov_b32 s83, 0x20000
    s_and_b32 s60, s48, 31
    s_lshr_b32 s61, s48, 5
    s_mov_b32 s46, 3670016
    v_mul_u32_u24 v56, 56, v3
    s_mul_i32 s62, s61, 224
    s_mov_b32 s63, 229376
    v_mul_lo_u32 v57, s63, v3
    v_lshl_add_u32 v57, v2, 4, v57
    s_mul_i32 s63, s61, 917504
    s_lshl_b32 s64, s60, 8
    s_add_u32 s63, s63, s64
    s_and_b32 s56, s2, 0xf8
    s_waitcnt lgkmcnt(0)
    s_mov_b32 s36, s28
    s_mov_b32 s37, s29
    s_mov_b32 s80, s26
    s_mov_b32 s81, s27
    s_cmp_lg_u32 s2, 0
    s_cbranch_scc1 L_nononce
    s_or_b32 s92, s92, 1
    v_mov_b32 v60, s92
    v_mov_b32 v61, s93
    v_lshlrev_b32 v62, 3, v0
    s_mov_b32 exec_hi, 0
    buffer_store_dwordx2 v[60:61], v62, s[80:83], 0 offen sc1
    s_mov_b64 exec, -1
L_nononce:
    s_cmp_eq_u32 s55, 0
    s_cselect_b32 s40, s4, s14
    s_cselect_b32 s41, s5, s15
    s_cselect_b32 s44, s10, s20
    s_cselect_b32 s45, s11, s21
    buffer_load_dwordx4 v[64:67], v57, s[44:47], s63 offen nt
    s_add_u32 s63, s63, 8192
    buffer_load_dwordx2 v[16:17], v56, s[40:43], s62 offen offset:0
    buffer_load_dwordx2 v[18:19], v56, s[40:43], s62 offen offset:8
    buffer_load_dwordx2 v[20:21], v56, s[40:43], s62 offen offset:16
    buffer_load_dwordx2 v[22:23], v56, s[40:43], s62 offen offset:24
    buffer_load_dwordx2 v[24:25], v56, s[40:43], s62 offen offset:32
    buffer_load_dwordx2 v[26:27], v56, s[40:43], s62 offen offset:40
    buffer_load_dwordx2 v[28:29], v56, s[40:43], s62 offen offset:48
    buffer_load_dwordx4 v[68:71], v57, s[44:47], s63 offen nt
    s_add_u32 s63, s63, 8192
    buffer_load_dwordx4 v[72:75], v57, s[44:47], s63 offen nt
    s_add_u32 s63, s63, 8192
    buffer_load_dwordx4 v[76:79], v57, s[44:47], s63 offen nt
    s_add_u32 s63, s63, 8192
    buffer_load_dwordx4 v[80:83], v57, s[44:47], s63 offen nt
    s_add_u32 s63, s63, 8192
    buffer_load_dwordx4 v[84:87], v57, s[44:47], s63 offen nt
    s_add_u32 s63, s63, 8192
    buffer_load_dwordx4 v[88:91], v57, s[44:47], s63 offen nt
    s_add_u32 s63, s63, 8192
    buffer_load_dwordx4 v[92:95], v57, s[44:47], s63 offen nt
    s_add_u32 s63, s63, 8192
    buffer_load_dwordx4 v[96:99], v57, s[44:47], s63 offen nt
    s_add_u32 s63, s63, 8192
    buffer_load_dwordx4 v[100:103], v57, s[44:47], s63 offen nt
    s_add_u32 s63, s63, 8192
    buffer_load_dwordx4 v[104:107], v57, s[44:47], s63 offen nt
    s_add_u32 s63, s63, 8192
    buffer_load_dwordx4 v[108:111], v57, s[44:47], s63 offen nt
    s_add_u32 s63, s63, 8192
    buffer_load_dwordx4 v[112:115], v57, s[44:47], s63 offen nt
    s_add_u32 s63, s63, 8192
    buffer_load_dwordx4 v[116:119], v57, s[44:47], s63 offen nt
    s_add_u32 s63, s63, 8192
    buffer_load_dwordx4 v[120:123], v57, s[44:47], s63 offen nt
    s_add_u32 s63, s63, 8192
    buffer_load_dwordx4 v[124:127], v57, s[44:47], s63 offen nt
    s_add_u32 s63, s63, 8192
    buffer_load_dwordx4 v[128:131], v57, s[44:47], s63 offen nt
    s_add_u32 s63, s63, 8192
    buffer_load_dwordx4 v[132:135], v57, s[44:47], s63 offen nt
    s_add_u32 s63, s63, 8192
    buffer_load_dwordx4 v[136:139], v57, s[44:47], s63 offen nt
    s_add_u32 s63, s63, 8192
    buffer_load_dwordx4 v[140:143], v57, s[44:47], s63 offen nt
    s_add_u32 s63, s63, 8192
    buffer_load_dwordx4 v[144:147], v57, s[44:47], s63 offen nt
    s_add_u32 s63, s63, 8192
    buffer_load_dwordx4 v[148:151], v57, s[44:47], s63 offen nt
    s_add_u32 s63, s63, 8192
    buffer_load_dwordx4 v[152:155], v57, s[44:47], s63 offen nt
    s_add_u32 s63, s63, 8192
    buffer_load_dwordx4 v[156:159], v57, s[44:47], s63 offen nt
    s_add_u32 s63, s63, 8192
    buffer_load_dwordx4 v[160:163], v57, s[44:47], s63 offen nt
    s_add_u32 s63, s63, 8192
    buffer_load_dwordx4 v[164:167], v57, s[44:47], s63 offen nt
    s_add_u32 s63, s63, 8192
    buffer_load_dwordx4 v[168:171], v57, s[44:47], s63 offen nt
    s_add_u32 s63, s63, 8192
    buffer_load_dwordx4 v[172:175], v57, s[44:47], s63 offen nt
    s_barrier
    buffer_load_dwordx2 v[60:61], off, s[80:83], s56 sc1
    v_and_b32 v4, 1, v0
    v_cmp_eq_u32 vcc, 1, v4
    v_mov_b32 v5, 0x0c0c0100
    v_mov_b32 v6, 0x01000c0c
    v_cndmask_b32 v5, v5, v6, vcc
    v_mov_b32 v6, 0x0c0c0302
    v_mov_b32 v7, 0x03020c0c
    v_cndmask_b32 v6, v6, v7, vcc
    v_bfe_u32 v4, v0, 1, 2
    v_mov_b32 v7, 0x0c0c0c0c
    v_cmp_eq_u32 vcc, 0, v4
    s_nop 1
    v_cndmask_b32 v8, v7, v5, vcc
    v_cndmask_b32 v12, v7, v6, vcc
    v_cmp_eq_u32 vcc, 1, v4
    s_nop 1
    v_cndmask_b32 v9, v7, v5, vcc
    v_cndmask_b32 v13, v7, v6, vcc
    v_cmp_eq_u32 vcc, 2, v4
    s_nop 1
    v_cndmask_b32 v10, v7, v5, vcc
    v_cndmask_b32 v14, v7, v6, vcc
    v_cmp_eq_u32 vcc, 3, v4
    s_nop 1
    v_cndmask_b32 v11, v7, v5, vcc
    v_cndmask_b32 v15, v7, v6, vcc
    v_mov_b32 v44, 1536
    v_mov_b32 v46, 0
    v_mov_b32 v47, 0
    ds_write_b64 v44, v[46:47]
    ds_write_b64 v44, v[46:47] offset:8
    v_lshlrev_b32 v58, 4, v0
    v_and_b32 v59, 1, v3
    v_lshlrev_b32 v59, 4, v59
    v_lshl_add_u32 v59, v2, 5, v59
    v_lshrrev_b32 v62, 5, v0
    v_lshlrev_b32 v62, 4, v62
    v_lshl_add_u32 v62, v59, 1, v62
    s_lshl_b32 s63, s61, 15
    s_lshl_b32 s64, s60, 10
    s_add_u32 s63, s63, s64
    s_lshl_b32 s64, s55, 17
    s_add_u32 s63, s63, s64
    s_add_u32 s63, s63, 65536
    s_waitcnt vmcnt(28)
    v_perm_b32 v32, v16, v16, v8
    v_perm_b32 v33, v16, v16, v9
    v_perm_b32 v34, v16, v16, v10
    v_perm_b32 v35, v16, v16, v11
    s_nop 1
    v_mfma_f32_16x16x32_bf16 v[40:43], v[32:35], v[64:67], 0
    s_waitcnt vmcnt(27)
    v_perm_b32 v36, v16, v16, v12
    v_perm_b32 v37, v16, v16, v13
    v_perm_b32 v38, v16, v16, v14
    v_perm_b32 v39, v16, v16, v15
    s_nop 1
    v_mfma_f32_16x16x32_bf16 v[40:43], v[36:39], v[68:71], v[40:43]
    s_waitcnt vmcnt(26)
    v_perm_b32 v32, v17, v17, v8
    v_perm_b32 v33, v17, v17, v9
    v_perm_b32 v34, v17, v17, v10
    v_perm_b32 v35, v17, v17, v11
    s_nop 1
    v_mfma_f32_16x16x32_bf16 v[40:43], v[32:35], v[72:75], v[40:43]
    s_waitcnt vmcnt(25)
    v_perm_b32 v36, v17, v17, v12
    v_perm_b32 v37, v17, v17, v13
    v_perm_b32 v38, v17, v17, v14
    v_perm_b32 v39, v17, v17, v15
    s_nop 1
    v_mfma_f32_16x16x32_bf16 v[40:43], v[36:39], v[76:79], v[40:43]
    s_waitcnt vmcnt(24)
    v_perm_b32 v32, v18, v18, v8
    v_perm_b32 v33, v18, v18, v9
    v_perm_b32 v34, v18, v18, v10
    v_perm_b32 v35, v18, v18, v11
    s_nop 1
    v_mfma_f32_16x16x32_bf16 v[40:43], v[32:35], v[80:83], v[40:43]
    s_waitcnt vmcnt(23)
    v_perm_b32 v36, v18, v18, v12
    v_perm_b32 v37, v18, v18, v13
    v_perm_b32 v38, v18, v18, v14
    v_perm_b32 v39, v18, v18, v15
    s_nop 1
    v_mfma_f32_16x16x32_bf16 v[40:43], v[36:39], v[84:87], v[40:43]
    s_waitcnt vmcnt(22)
    v_perm_b32 v32, v19, v19, v8
    v_perm_b32 v33, v19, v19, v9
    v_perm_b32 v34, v19, v19, v10
    v_perm_b32 v35, v19, v19, v11
    s_nop 1
    v_mfma_f32_16x16x32_bf16 v[40:43], v[32:35], v[88:91], v[40:43]
    s_waitcnt vmcnt(21)
    v_perm_b32 v36, v19, v19, v12
    v_perm_b32 v37, v19, v19, v13
    v_perm_b32 v38, v19, v19, v14
    v_perm_b32 v39, v19, v19, v15
    s_nop 1
    v_mfma_f32_16x16x32_bf16 v[40:43], v[36:39], v[92:95], v[40:43]
    s_waitcnt vmcnt(20)
    v_perm_b32 v32, v20, v20, v8
    v_perm_b32 v33, v20, v20, v9
    v_perm_b32 v34, v20, v20, v10
    v_perm_b32 v35, v20, v20, v11
    s_nop 1
    v_mfma_f32_16x16x32_bf16 v[40:43], v[32:35], v[96:99], v[40:43]
    s_waitcnt vmcnt(19)
    v_perm_b32 v36, v20, v20, v12
    v_perm_b32 v37, v20, v20, v13
    v_perm_b32 v38, v20, v20, v14
    v_perm_b32 v39, v20, v20, v15
    s_nop 1
    v_mfma_f32_16x16x32_bf16 v[40:43], v[36:39], v[100:103], v[40:43]
    s_waitcnt vmcnt(18)
    v_perm_b32 v32, v21, v21, v8
    v_perm_b32 v33, v21, v21, v9
    v_perm_b32 v34, v21, v21, v10
    v_perm_b32 v35, v21, v21, v11
    s_nop 1
    v_mfma_f32_16x16x32_bf16 v[40:43], v[32:35], v[104:107], v[40:43]
    s_waitcnt vmcnt(17)
    v_perm_b32 v36, v21, v21, v12
    v_perm_b32 v37, v21, v21, v13
    v_perm_b32 v38, v21, v21, v14
    v_perm_b32 v39, v21, v21, v15
    s_nop 1
    v_mfma_f32_16x16x32_bf16 v[40:43], v[36:39], v[108:111], v[40:43]
    s_waitcnt vmcnt(16)
    v_perm_b32 v32, v22, v22, v8
    v_perm_b32 v33, v22, v22, v9
    v_perm_b32 v34, v22, v22, v10
    v_perm_b32 v35, v22, v22, v11
    s_nop 1
    v_mfma_f32_16x16x32_bf16 v[40:43], v[32:35], v[112:115], v[40:43]
    s_waitcnt vmcnt(15)
    v_perm_b32 v36, v22, v22, v12
    v_perm_b32 v37, v22, v22, v13
    v_perm_b32 v38, v22, v22, v14
    v_perm_b32 v39, v22, v22, v15
    s_nop 1
    v_mfma_f32_16x16x32_bf16 v[40:43], v[36:39], v[116:119], v[40:43]
    s_waitcnt vmcnt(14)
    v_perm_b32 v32, v23, v23, v8
    v_perm_b32 v33, v23, v23, v9
    v_perm_b32 v34, v23, v23, v10
    v_perm_b32 v35, v23, v23, v11
    s_nop 1
    v_mfma_f32_16x16x32_bf16 v[40:43], v[32:35], v[120:123], v[40:43]
    s_waitcnt vmcnt(13)
    v_perm_b32 v36, v23, v23, v12
    v_perm_b32 v37, v23, v23, v13
    v_perm_b32 v38, v23, v23, v14
    v_perm_b32 v39, v23, v23, v15
    s_nop 1
    v_mfma_f32_16x16x32_bf16 v[40:43], v[36:39], v[124:127], v[40:43]
    s_waitcnt vmcnt(12)
    v_perm_b32 v32, v24, v24, v8
    v_perm_b32 v33, v24, v24, v9
    v_perm_b32 v34, v24, v24, v10
    v_perm_b32 v35, v24, v24, v11
    s_nop 1
    v_mfma_f32_16x16x32_bf16 v[40:43], v[32:35], v[128:131], v[40:43]
    s_waitcnt vmcnt(11)
    v_perm_b32 v36, v24, v24, v12
    v_perm_b32 v37, v24, v24, v13
    v_perm_b32 v38, v24, v24, v14
    v_perm_b32 v39, v24, v24, v15
    s_nop 1
    v_mfma_f32_16x16x32_bf16 v[40:43], v[36:39], v[132:135], v[40:43]
    s_waitcnt vmcnt(10)
    v_perm_b32 v32, v25, v25, v8
    v_perm_b32 v33, v25, v25, v9
    v_perm_b32 v34, v25, v25, v10
    v_perm_b32 v35, v25, v25, v11
    s_nop 1
    v_mfma_f32_16x16x32_bf16 v[40:43], v[32:35], v[136:139], v[40:43]
    s_waitcnt vmcnt(9)
    v_perm_b32 v36, v25, v25, v12
    v_perm_b32 v37, v25, v25, v13
    v_perm_b32 v38, v25, v25, v14
    v_perm_b32 v39, v25, v25, v15
    s_nop 1
    v_mfma_f32_16x16x32_bf16 v[40:43], v[36:39], v[140:143], v[40:43]
    s_waitcnt vmcnt(8)
    v_perm_b32 v32, v26, v26, v8
    v_perm_b32 v33, v26, v26, v9
    v_perm_b32 v34, v26, v26, v10
    v_perm_b32 v35, v26, v26, v11
    s_nop 1
    v_mfma_f32_16x16x32_bf16 v[40:43], v[32:35], v[144:147], v[40:43]
    s_waitcnt vmcnt(7)
    v_perm_b32 v36, v26, v26, v12
    v_perm_b32 v37, v26, v26, v13
    v_perm_b32 v38, v26, v26, v14
    v_perm_b32 v39, v26, v26, v15
    s_nop 1
    v_mfma_f32_16x16x32_bf16 v[40:43], v[36:39], v[148:151], v[40:43]
    s_waitcnt vmcnt(6)
    v_perm_b32 v32, v27, v27, v8
    v_perm_b32 v33, v27, v27, v9
    v_perm_b32 v34, v27, v27, v10
    v_perm_b32 v35, v27, v27, v11
    s_nop 1
    v_mfma_f32_16x16x32_bf16 v[40:43], v[32:35], v[152:155], v[40:43]
    s_waitcnt vmcnt(5)
    v_perm_b32 v36, v27, v27, v12
    v_perm_b32 v37, v27, v27, v13
    v_perm_b32 v38, v27, v27, v14
    v_perm_b32 v39, v27, v27, v15
    s_nop 1
    v_mfma_f32_16x16x32_bf16 v[40:43], v[36:39], v[156:159], v[40:43]
    s_waitcnt vmcnt(4)
    v_perm_b32 v32, v28, v28, v8
    v_perm_b32 v33, v28, v28, v9
    v_perm_b32 v34, v28, v28, v10
    v_perm_b32 v35, v28, v28, v11
    s_nop 1
    v_mfma_f32_16x16x32_bf16 v[40:43], v[32:35], v[160:163], v[40:43]
    s_waitcnt vmcnt(3)
    v_perm_b32 v36, v28, v28, v12
    v_perm_b32 v37, v28, v28, v13
    v_perm_b32 v38, v28, v28, v14
    v_perm_b32 v39, v28, v28, v15
    s_nop 1
    v_mfma_f32_16x16x32_bf16 v[40:43], v[36:39], v[164:167], v[40:43]
    s_waitcnt vmcnt(2)
    v_perm_b32 v32, v29, v29, v8
    v_perm_b32 v33, v29, v29, v9
    v_perm_b32 v34, v29, v29, v10
    v_perm_b32 v35, v29, v29, v11
    s_nop 1
    v_mfma_f32_16x16x32_bf16 v[40:43], v[32:35], v[168:171], v[40:43]
    s_waitcnt vmcnt(1)
    v_perm_b32 v36, v29, v29, v12
    v_perm_b32 v37, v29, v29, v13
    v_perm_b32 v38, v29, v29, v14
    v_perm_b32 v39, v29, v29, v15
    s_nop 1
    v_mfma_f32_16x16x32_bf16 v[40:43], v[36:39], v[172:175], v[40:43]
    s_mov_b32 s65, 1048576
    s_nop 6
L_np:
    s_waitcnt vmcnt(0)
    v_readfirstlane_b32 s92, v60
    v_readfirstlane_b32 s93, v61
    s_cmp_lg_u32 s92, 0
    s_nop 3
    s_cbranch_scc1 L_nd
    buffer_load_dwordx2 v[60:61], off, s[80:83], s56 sc1
    s_sub_u32 s65, s65, 1
    s_cmp_lg_u32 s65, 0
    s_cbranch_scc1 L_np
L_nd:
    s_mov_b32 exec_lo, 0
    v_mov_b32 v40, v42
    v_mov_b32 v41, v43
    s_mov_b32 exec_lo, -1
    v_mov_b32 v42, v60
    v_mov_b32 v43, v61
    buffer_store_dwordx4 v[40:43], v62, s[36:39], s63 offen sc1
    v_mov_b32 v56, 1552
    ds_write_b64 v56, v[60:61]
    s_sleep 40
    s_mov_b32 s65, 1048576
L_ga:
    s_lshl_b32 s62, s97, 12
    s_add_u32 s62, s62, 65536
    buffer_load_dwordx4 v[192:195], v58, s[36:39], s62 offen offset:0 sc1
    buffer_load_dwordx4 v[196:199], v58, s[36:39], s62 offen offset:1024 sc1
    buffer_load_dwordx4 v[200:203], v58, s[36:39], s62 offen offset:2048 sc1
    buffer_load_dwordx4 v[204:207], v58, s[36:39], s62 offen offset:3072 sc1
    s_add_u32 s62, s62, 0x8000
    buffer_load_dwordx4 v[208:211], v58, s[36:39], s62 offen offset:0 sc1
    buffer_load_dwordx4 v[212:215], v58, s[36:39], s62 offen offset:1024 sc1
    buffer_load_dwordx4 v[216:219], v58, s[36:39], s62 offen offset:2048 sc1
    buffer_load_dwordx4 v[220:223], v58, s[36:39], s62 offen offset:3072 sc1
    s_add_u32 s62, s62, 0x8000
    buffer_load_dwordx4 v[224:227], v58, s[36:39], s62 offen offset:0 sc1
    buffer_load_dwordx4 v[228:231], v58, s[36:39], s62 offen offset:1024 sc1
    buffer_load_dwordx4 v[232:235], v58, s[36:39], s62 offen offset:2048 sc1
    buffer_load_dwordx4 v[236:239], v58, s[36:39], s62 offen offset:3072 sc1
    s_add_u32 s62, s62, 0x8000
    buffer_load_dwordx4 v[240:243], v58, s[36:39], s62 offen offset:0 sc1
    buffer_load_dwordx4 v[244:247], v58, s[36:39], s62 offen offset:1024 sc1
    buffer_load_dwordx4 v[248:251], v58, s[36:39], s62 offen offset:2048 sc1
    buffer_load_dwordx4 v[252:255], v58, s[36:39], s62 offen offset:3072 sc1
    s_mov_b64 s[66:67], 0
    s_waitcnt vmcnt(15)
    v_cmp_ne_u64 vcc, s[92:93], v[194:195]
    s_or_b64 s[66:67], s[66:67], vcc
    s_waitcnt vmcnt(14)
    v_cmp_ne_u64 vcc, s[92:93], v[198:199]
    s_or_b64 s[66:67], s[66:67], vcc
    s_waitcnt vmcnt(13)
    v_cmp_ne_u64 vcc, s[92:93], v[202:203]
    s_or_b64 s[66:67], s[66:67], vcc
    s_waitcnt vmcnt(12)
    v_cmp_ne_u64 vcc, s[92:93], v[206:207]
    s_or_b64 s[66:67], s[66:67], vcc
    s_waitcnt vmcnt(11)
    v_cmp_ne_u64 vcc, s[92:93], v[210:211]
    s_or_b64 s[66:67], s[66:67], vcc
    s_waitcnt vmcnt(10)
    v_cmp_ne_u64 vcc, s[92:93], v[214:215]
    s_or_b64 s[66:67], s[66:67], vcc
    s_waitcnt vmcnt(9)
    v_cmp_ne_u64 vcc, s[92:93], v[218:219]
    s_or_b64 s[66:67], s[66:67], vcc
    s_waitcnt vmcnt(8)
    v_cmp_ne_u64 vcc, s[92:93], v[222:223]
    s_or_b64 s[66:67], s[66:67], vcc
    s_waitcnt vmcnt(7)
    v_cmp_ne_u64 vcc, s[92:93], v[226:227]
    s_or_b64 s[66:67], s[66:67], vcc
    s_waitcnt vmcnt(6)
    v_cmp_ne_u64 vcc, s[92:93], v[230:231]
    s_or_b64 s[66:67], s[66:67], vcc
    s_waitcnt vmcnt(5)
    v_cmp_ne_u64 vcc, s[92:93], v[234:235]
    s_or_b64 s[66:67], s[66:67], vcc
    s_waitcnt vmcnt(4)
    v_cmp_ne_u64 vcc, s[92:93], v[238:239]
    s_or_b64 s[66:67], s[66:67], vcc
    s_waitcnt vmcnt(3)
    v_cmp_ne_u64 vcc, s[92:93], v[242:243]
    s_or_b64 s[66:67], s[66:67], vcc
    s_waitcnt vmcnt(2)
    v_cmp_ne_u64 vcc, s[92:93], v[246:247]
    s_or_b64 s[66:67], s[66:67], vcc
    s_waitcnt vmcnt(1)
    v_cmp_ne_u64 vcc, s[92:93], v[250:251]
    s_or_b64 s[66:67], s[66:67], vcc
    s_waitcnt vmcnt(0)
    v_cmp_ne_u64 vcc, s[92:93], v[254:255]
    s_or_b64 s[66:67], s[66:67], vcc
    s_cmp_eq_u64 s[66:67], 0
    s_nop 2
    s_cbranch_scc1 L_gad
    s_sleep 8
    s_sub_u32 s65, s65, 1
    s_cmp_lg_u32 s65, 0
    s_cbranch_scc1 L_ga
L_gad:
    v_pk_add_f32 v[192:193], v[192:193], v[208:209]
    v_pk_add_f32 v[224:225], v[224:225], v[240:241]
    v_pk_add_f32 v[196:197], v[196:197], v[212:213]
    v_pk_add_f32 v[228:229], v[228:229], v[244:245]
    v_pk_add_f32 v[200:201], v[200:201], v[216:217]
    v_pk_add_f32 v[232:233], v[232:233], v[248:249]
    v_pk_add_f32 v[204:205], v[204:205], v[220:221]
    v_pk_add_f32 v[236:237], v[236:237], v[252:253]
    v_pk_add_f32 v[192:193], v[192:193], v[224:225]
    v_pk_add_f32 v[196:197], v[196:197], v[228:229]
    v_pk_add_f32 v[200:201], v[200:201], v[232:233]
    v_pk_add_f32 v[204:205], v[204:205], v[236:237]
    v_lshlrev_b32 v56, 2, v0
    v_cvt_pk_bf16_f32 v194, v192, v193
    v_cvt_pk_bf16_f32 v198, v196, v197
    v_cvt_pk_bf16_f32 v202, v200, v201
    v_cvt_pk_bf16_f32 v206, v204, v205
    ds_write_b32 v56, v194 offset:0
    ds_write_b32 v56, v198 offset:256
    ds_write_b32 v56, v202 offset:512
    ds_write_b32 v56, v206 offset:768
    s_waitcnt lgkmcnt(0)
    s_barrier
    s_setprio 0
    s_lshl_b32 s60, s55, 7
    s_add_u32 s60, s60, s48
    s_lshl_b32 s52, s60, 12
    s_add_u32 s52, s52, 524288
    s_lshl_b32 s54, s60, 11
    s_add_u32 s54, s54, 1572864
    s_cmp_ge_u32 s60, 16
    s_cbranch_scc1 L_notk
    s_lshl_b32 s63, s60, 8
    s_add_u32 s63, s63, 327680
    v_mov_b32 v40, 0
    v_mov_b32 v41, 0
    s_mov_b64 exec, 1
    buffer_store_dwordx4 v[40:43], off, s[36:39], s63 sc1
    s_mov_b64 exec, -1
    s_nop 0
L_notk:
    s_cmp_eq_u32 s55, 1
    s_cselect_b32 s44, s22, s12
    s_cselect_b32 s45, s23, s13
    s_mov_b32 s46, 3670016
    s_mul_i32 s63, s48, 28672
    v_bfrev_b32 v63, v3
    v_lshrrev_b32 v63, 30, v63
    v_mul_u32_u24 v56, 896, v63
    v_lshl_add_u32 v56, v2, 4, v56
    s_mov_b32 s66, 0x00ff00ff
    s_mov_b32 s67, 0x00ff00ff
    buffer_load_dwordx4 v[64:67], v56, s[44:47], s63 offen offset:0 nt
    buffer_load_dwordx4 v[68:71], v56, s[44:47], s63 offen offset:256 nt
    buffer_load_dwordx4 v[72:75], v56, s[44:47], s63 offen offset:512 nt
    s_mov_b64 exec, s[66:67]
    buffer_load_dwordx4 v[76:79], v56, s[44:47], s63 offen offset:768 nt
    s_mov_b64 exec, -1
    s_add_u32 s63, s63, 3584
    buffer_load_dwordx4 v[80:83], v56, s[44:47], s63 offen offset:0 nt
    buffer_load_dwordx4 v[84:87], v56, s[44:47], s63 offen offset:256 nt
    buffer_load_dwordx4 v[88:91], v56, s[44:47], s63 offen offset:512 nt
    s_mov_b64 exec, s[66:67]
    buffer_load_dwordx4 v[92:95], v56, s[44:47], s63 offen offset:768 nt
    s_mov_b64 exec, -1
    s_add_u32 s63, s63, 3584
    buffer_load_dwordx4 v[96:99], v56, s[44:47], s63 offen offset:0 nt
    buffer_load_dwordx4 v[100:103], v56, s[44:47], s63 offen offset:256 nt
    buffer_load_dwordx4 v[104:107], v56, s[44:47], s63 offen offset:512 nt
    s_mov_b64 exec, s[66:67]
    buffer_load_dwordx4 v[108:111], v56, s[44:47], s63 offen offset:768 nt
    s_mov_b64 exec, -1
    s_add_u32 s63, s63, 3584
    buffer_load_dwordx4 v[112:115], v56, s[44:47], s63 offen offset:0 nt
    buffer_load_dwordx4 v[116:119], v56, s[44:47], s63 offen offset:256 nt
    buffer_load_dwordx4 v[120:123], v56, s[44:47], s63 offen offset:512 nt
    s_mov_b64 exec, s[66:67]
    buffer_load_dwordx4 v[124:127], v56, s[44:47], s63 offen offset:768 nt
    s_mov_b64 exec, -1
    s_add_u32 s63, s63, 3584
    buffer_load_dwordx4 v[128:131], v56, s[44:47], s63 offen offset:0 nt
    buffer_load_dwordx4 v[132:135], v56, s[44:47], s63 offen offset:256 nt
    buffer_load_dwordx4 v[136:139], v56, s[44:47], s63 offen offset:512 nt
    s_mov_b64 exec, s[66:67]
    buffer_load_dwordx4 v[140:143], v56, s[44:47], s63 offen offset:768 nt
    s_mov_b64 exec, -1
    s_add_u32 s63, s63, 3584
    buffer_load_dwordx4 v[144:147], v56, s[44:47], s63 offen offset:0 nt
    buffer_load_dwordx4 v[148:151], v56, s[44:47], s63 offen offset:256 nt
    buffer_load_dwordx4 v[152:155], v56, s[44:47], s63 offen offset:512 nt
    s_mov_b64 exec, s[66:67]
    buffer_load_dwordx4 v[156:159], v56, s[44:47], s63 offen offset:768 nt
    s_mov_b64 exec, -1
    s_add_u32 s63, s63, 3584
    buffer_load_dwordx4 v[160:163], v56, s[44:47], s63 offen offset:0 nt
    buffer_load_dwordx4 v[164:167], v56, s[44:47], s63 offen offset:256 nt
    buffer_load_dwordx4 v[168:171], v56, s[44:47], s63 offen offset:512 nt
    s_mov_b64 exec, s[66:67]
    buffer_load_dwordx4 v[172:175], v56, s[44:47], s63 offen offset:768 nt
    s_mov_b64 exec, -1
    s_add_u32 s63, s63, 3584
    buffer_load_dwordx4 v[176:179], v56, s[44:47], s63 offen offset:0 nt
    buffer_load_dwordx4 v[180:183], v56, s[44:47], s63 offen offset:256 nt
    buffer_load_dwordx4 v[184:187], v56, s[44:47], s63 offen offset:512 nt
    s_mov_b64 exec, s[66:67]
    buffer_load_dwordx4 v[188:191], v56, s[44:47], s63 offen offset:768 nt
    s_mov_b64 exec, -1
    s_waitcnt vmcnt(0)
    s_lshl_b32 s64, s96, 8
    s_add_u32 s64, s64, 327680
    s_mov_b32 s65, 1048576
L_rd:
    buffer_load_dwordx2 v[192:193], off, s[36:39], s64 offset:8 sc1
    s_waitcnt vmcnt(0)
    v_cmp_ne_u64 vcc, s[92:93], v[192:193]
    s_cmp_eq_u64 vcc, 0
    s_nop 3
    s_cbranch_scc1 L_rdd
    s_sleep 64
    s_sub_u32 s65, s65, 1
    s_cmp_lg_u32 s65, 0
    s_cbranch_scc1 L_rd
L_rdd:
    s_mov_b32 s65, 1048576
L_gb:
    s_lshl_b32 s62, s96, 11
    s_add_u32 s62, s62, 196608
    buffer_load_dwordx4 v[192:195], v58, s[36:39], s62 offen offset:0 sc1
    buffer_load_dwordx4 v[196:199], v58, s[36:39], s62 offen offset:1024 sc1
    s_add_u32 s62, s62, 0x8000
    buffer_load_dwordx4 v[200:203], v58, s[36:39], s62 offen offset:0 sc1
    buffer_load_dwordx4 v[204:207], v58, s[36:39], s62 offen offset:1024 sc1
    s_add_u32 s62, s62, 0x8000
    buffer_load_dwordx4 v[208:211], v58, s[36:39], s62 offen offset:0 sc1
    buffer_load_dwordx4 v[212:215], v58, s[36:39], s62 offen offset:1024 sc1
    s_add_u32 s62, s62, 0x8000
    buffer_load_dwordx4 v[216:219], v58, s[36:39], s62 offen offset:0 sc1
    buffer_load_dwordx4 v[220:223], v58, s[36:39], s62 offen offset:1024 sc1
    s_mov_b64 s[66:67], 0
    s_waitcnt vmcnt(7)
    v_cmp_ne_u64 vcc, s[92:93], v[194:195]
    s_or_b64 s[66:67], s[66:67], vcc
    s_waitcnt vmcnt(6)
    v_cmp_ne_u64 vcc, s[92:93], v[198:199]
    s_or_b64 s[66:67], s[66:67], vcc
    s_waitcnt vmcnt(5)
    v_cmp_ne_u64 vcc, s[92:93], v[202:203]
    s_or_b64 s[66:67], s[66:67], vcc
    s_waitcnt vmcnt(4)
    v_cmp_ne_u64 vcc, s[92:93], v[206:207]
    s_or_b64 s[66:67], s[66:67], vcc
    s_waitcnt vmcnt(3)
    v_cmp_ne_u64 vcc, s[92:93], v[210:211]
    s_or_b64 s[66:67], s[66:67], vcc
    s_waitcnt vmcnt(2)
    v_cmp_ne_u64 vcc, s[92:93], v[214:215]
    s_or_b64 s[66:67], s[66:67], vcc
    s_waitcnt vmcnt(1)
    v_cmp_ne_u64 vcc, s[92:93], v[218:219]
    s_or_b64 s[66:67], s[66:67], vcc
    s_waitcnt vmcnt(0)
    v_cmp_ne_u64 vcc, s[92:93], v[222:223]
    s_or_b64 s[66:67], s[66:67], vcc
    s_cmp_eq_u64 s[66:67], 0
    s_nop 2
    s_cbranch_scc1 L_gbd
    s_sleep 64
    s_sub_u32 s65, s65, 1
    s_cmp_lg_u32 s65, 0
    s_cbranch_scc1 L_gb
L_gbd:
    v_pk_add_f32 v[192:193], v[192:193], v[200:201]
    v_pk_add_f32 v[208:209], v[208:209], v[216:217]
    v_pk_add_f32 v[196:197], v[196:197], v[204:205]
    v_pk_add_f32 v[212:213], v[212:213], v[220:221]
    v_pk_add_f32 v[192:193], v[192:193], v[208:209]
    v_pk_add_f32 v[196:197], v[196:197], v[212:213]
    v_lshlrev_b32 v56, 2, v0
    v_cvt_pk_bf16_f32 v194, v192, v193
    v_cvt_pk_bf16_f32 v198, v196, v197
    ds_write_b32 v56, v194 offset:1024
    ds_write_b32 v56, v198 offset:1280
    s_waitcnt lgkmcnt(0)
    v_mov_b32 v56, 1540
    v_mov_b32 v57, 1
    ds_write_b32 v56, v57
    s_and_b32 s4, s92, 0x7ff
    s_lshr_b32 s5, s92, 11
    s_lshr_b32 s6, s92, 22
    s_lshl_b32 s7, s93, 10
    s_or_b32 s6, s6, s7
    s_lshr_b32 s7, s93, 1
    s_xor_b32 s5, s5, s4
    s_and_b32 s5, s5, 0x7ff
    s_xor_b32 s6, s6, s4
    s_and_b32 s6, s6, 0x7ff
    s_xor_b32 s7, s7, s4
    s_and_b32 s7, s7, 0x7ff
    s_sub_u32 s8, 0x800, s4
    s_sub_u32 s9, 0x800, s5
    s_sub_u32 s10, 0x800, s6
    s_sub_u32 s11, 0x800, s7
    v_mov_b32 v24, 0xfffff000
    v_lshlrev_b32 v1, 1, v63
    v_and_b32 v57, 3, v0
    v_lshl_add_u32 v1, v57, 3, v1
    v_lshrrev_b32 v63, 2, v0
    v_lshlrev_b32 v63, 11, v63
    v_lshl_add_u32 v63, v57, 4, v63
    s_lshl_b32 s84, s48, 6
    s_lshl_b32 s60, s55, 18
    s_add_u32 s84, s84, s60
    s_add_u32 s84, s84, 1572864
    s_add_u32 s85, s84, 32768
    s_add_u32 s86, s85, 32768
    s_add_u32 s87, s86, 32768
    s_add_u32 s88, s87, 32768
    s_add_u32 s89, s88, 32768
    s_add_u32 s90, s89, 32768
    s_add_u32 s91, s90, 32768
    s_mov_b32 s40, s24
    s_mov_b32 s41, s25
    s_mov_b32 s42, 1792
    s_lshl_b32 s62, s48, 5
    s_mul_i32 s60, s55, 896
    s_add_u32 s62, s62, s60
    v_mov_b32 v56, 1544
    s_mov_b32 s65, 1048576
    s_nop 0
L_mw:
    ds_read_b32 v57, v56
    s_waitcnt lgkmcnt(0)
    v_readfirstlane_b32 s64, v57
    s_cmp_ge_u32 s64, 3
    s_nop 3
    s_cbranch_scc1 L_mwd
    s_sleep 32
    s_sub_u32 s65, s65, 1
    s_cmp_lg_u32 s65, 0
    s_cbranch_scc1 L_mw
L_mwd:
    v_lshlrev_b32 v56, 3, v0
    ds_read_b128 v[192:195], v58 offset:7168
    ds_read_b128 v[196:199], v58 offset:8192
    ds_read_b64 v[200:201], v56 offset:9216
    v_and_b32 v224, 0x7f, v59
    v_lshrrev_b32 v225, 2, v2
    v_lshl_add_u32 v224, v225, 12, v224
    v_lshrrev_b32 v225, 5, v0
    v_lshl_add_u32 v224, v225, 15, v224
    s_and_b32 s65, s2, 31
    s_lshl_b32 s98, s97, 16
    s_lshl_b32 s47, s65, 7
    s_add_u32 s98, s98, s47
    s_add_u32 s98, s98, 524288
    s_add_u32 s47, s98, 0x4000
    v_and_b32 v225, 1, v3
    v_mul_u32_u24 v225, 12, v225
    v_sub_u32 v225, 20, v225
    s_mov_b32 s12, 0xaaaaaaaa
    s_mov_b32 s13, 0xaaaaaaaa
    s_waitcnt lgkmcnt(0)
    v_mov_b32_dpp v202, v200 row_newbcast:0 row_mask:0x3 bank_mask:0xf
    v_mov_b32_dpp v202, v200 row_newbcast:8 row_mask:0xc bank_mask:0xf
    v_mov_b32_dpp v203, v201 row_newbcast:0 row_mask:0x3 bank_mask:0xf
    v_mov_b32_dpp v203, v201 row_newbcast:8 row_mask:0xc bank_mask:0xf
    v_add_u32 v203, 0x80, v203
    v_cndmask_b32 v200, v202, v203, s[12:13]
    v_bfe_u32 v200, v200, v225, 12
    v_add_u32 v192, s8, v192
    v_add_u32 v193, s9, v193
    v_add_u32 v194, s10, v194
    v_add_u32 v195, 0x800, v195
    v_add_u32 v196, s8, v196
    v_add_u32 v197, s9, v197
    v_add_u32 v198, s10, v198
    v_add_u32 v199, 0x800, v199
    v_and_or_b32 v192, v192, v24, s4
    v_and_or_b32 v193, v193, v24, s5
    v_and_or_b32 v194, v194, v24, s6
    v_and_or_b32 v195, v195, v24, v200
    v_and_or_b32 v196, v196, v24, s4
    v_and_or_b32 v197, v197, v24, s5
    v_and_or_b32 v198, v198, v24, s6
    v_and_or_b32 v199, v199, v24, v200
    v_and_b32 v62, 1, v0
    v_mul_u32_u24 v62, 12, v62
    s_mov_b32 s14, 1035512379
    v_mov_b32 v56, 1548
    s_mov_b32 s65, 1048576
    s_nop 0
L_aw:
    ds_read_b32 v57, v56
    s_waitcnt lgkmcnt(0)
    v_readfirstlane_b32 s64, v57
    s_cmp_ge_u32 s64, 1
    s_nop 3
    s_cbranch_scc1 L_awd
    s_sleep 2
    s_sub_u32 s65, s65, 1
    s_cmp_lg_u32 s65, 0
    s_cbranch_scc1 L_aw
L_awd:
    buffer_store_dwordx4 v[192:195], v224, s[36:39], s98 offen sc1
    buffer_store_dwordx4 v[196:199], v224, s[36:39], s47 offen sc1
    s_cmp_eq_u32 s55, 0
    s_cselect_b32 s57, 2, 2
    v_mov_b32 v56, 1536
    s_mov_b32 s65, 1048576
    s_nop 0
L_ow:
    ds_read_b32 v57, v56
    s_waitcnt lgkmcnt(0)
    v_readfirstlane_b32 s64, v57
    s_cmp_ge_u32 s64, s57
    s_nop 3
    s_cbranch_scc1 L_owd
    s_sleep 2
    s_sub_u32 s65, s65, 1
    s_cmp_lg_u32 s65, 0
    s_cbranch_scc1 L_ow
L_owd:
    buffer_load_dwordx4 v[192:195], v58, s[36:39], s52 offen offset:0 sc1
    buffer_load_dwordx4 v[196:199], v58, s[36:39], s52 offen offset:1024 sc1
    buffer_load_dwordx4 v[200:203], v58, s[36:39], s52 offen offset:2048 sc1
    buffer_load_dwordx4 v[204:207], v58, s[36:39], s52 offen offset:3072 sc1
    s_waitcnt vmcnt(0)
    s_mov_b32 s65, 1048576
L_hp:
    v_xor_b32 v25, s4, v192
    v_xor_b32 v26, s5, v193
    v_xor_b32 v27, s6, v194
    v_bitop3_b32 v25, v196, s4, v25 bitop3:0xbe
    v_bitop3_b32 v26, v197, s5, v26 bitop3:0xbe
    v_bitop3_b32 v27, v198, s6, v27 bitop3:0xbe
    v_bitop3_b32 v25, v200, s4, v25 bitop3:0xbe
    v_bitop3_b32 v26, v201, s5, v26 bitop3:0xbe
    v_bitop3_b32 v27, v202, s6, v27 bitop3:0xbe
    v_bitop3_b32 v25, v204, s4, v25 bitop3:0xbe
    v_bitop3_b32 v26, v205, s5, v26 bitop3:0xbe
    v_bitop3_b32 v27, v206, s6, v27 bitop3:0xbe
    v_or3_b32 v25, v25, v26, v27
    v_and_b32 v25, 0xfff, v25
    v_cmp_ne_u32 vcc, 0, v25
    s_cmp_lg_u64 vcc, 0
    s_nop 3
    s_cbranch_scc0 L_hpd
    s_mov_b64 exec, vcc
    buffer_load_dwordx4 v[192:195], v58, s[36:39], s52 offen offset:0 sc1
    buffer_load_dwordx4 v[196:199], v58, s[36:39], s52 offen offset:1024 sc1
    buffer_load_dwordx4 v[200:203], v58, s[36:39], s52 offen offset:2048 sc1
    buffer_load_dwordx4 v[204:207], v58, s[36:39], s52 offen offset:3072 sc1
    s_mov_b64 exec, -1
    s_waitcnt vmcnt(48)
    s_sleep 1
    s_sub_u32 s65, s65, 1
    s_cmp_lg_u32 s65, 0
    s_cbranch_scc1 L_hp
L_hpd:
    v_lshlrev_b32 v240, 20, v195
    v_lshlrev_b32 v241, 20, v199
    v_lshlrev_b32 v242, 20, v203
    v_lshlrev_b32 v243, 20, v207
    v_lshrrev_b32 v240, v62, v240
    v_lshrrev_b32 v241, v62, v241
    v_lshrrev_b32 v242, v62, v242
    v_lshrrev_b32 v243, v62, v243
    v_or_b32_dpp v240, v240, v240 quad_perm:[1,0,3,2] row_mask:0xf bank_mask:0xf
    v_or_b32_dpp v241, v241, v241 quad_perm:[1,0,3,2] row_mask:0xf bank_mask:0xf
    v_or_b32_dpp v242, v242, v242 quad_perm:[1,0,3,2] row_mask:0xf bank_mask:0xf
    v_or_b32_dpp v243, v243, v243 quad_perm:[1,0,3,2] row_mask:0xf bank_mask:0xf
    v_mul_f32 v244, s14, v240
    v_mul_f32 v245, s14, v241
    v_mul_f32 v246, s14, v242
    v_mul_f32 v247, s14, v243
    v_max_f32 v224, v244, v245
    v_max3_f32 v224, v224, v246, v247
    v_and_b32 v248, v24, v195
    v_and_b32 v249, v24, v199
    v_max_f32_dpp v224, v224, v224 row_ror:8 row_mask:0xf bank_mask:0xf
    v_mov_b32 v227, v224
    v_and_b32 v250, v24, v203
    v_and_b32 v251, v24, v207
    v_permlane16_swap_b32 v224, v227
    v_max_f32 v224, v224, v227
    v_mov_b32 v227, v224
    s_nop 1
    v_permlane32_swap_b32 v224, v227
    v_max_f32 v224, v224, v227
    v_sub_f32 v244, v244, v224
    v_sub_f32 v245, v245, v224
    v_sub_f32 v246, v246, v224
    v_sub_f32 v247, v247, v224
    v_exp_f32 v244, v244
    v_exp_f32 v245, v245
    v_exp_f32 v246, v246
    v_exp_f32 v247, v247
    v_mul_f32_dpp v226, v244, v240 quad_perm:[0,0,0,0] row_mask:0xf bank_mask:0xf
    v_fmac_f32_dpp v226, v245, v241 quad_perm:[0,0,0,0] row_mask:0xf bank_mask:0xf
    v_fmac_f32_dpp v226, v246, v242 quad_perm:[0,0,0,0] row_mask:0xf bank_mask:0xf
    v_fmac_f32_dpp v226, v247, v243 quad_perm:[0,0,0,0] row_mask:0xf bank_mask:0xf
    v_mul_f32_dpp v228, v244, v192 quad_perm:[0,0,0,0] row_mask:0xf bank_mask:0xf
    v_mul_f32_dpp v229, v244, v193 quad_perm:[0,0,0,0] row_mask:0xf bank_mask:0xf
    v_mul_f32_dpp v230, v244, v194 quad_perm:[0,0,0,0] row_mask:0xf bank_mask:0xf
    v_mul_f32_dpp v231, v244, v248 quad_perm:[0,0,0,0] row_mask:0xf bank_mask:0xf
    v_mov_b32_dpp v226, v226 quad_perm:[2,2,2,2] row_mask:0xf bank_mask:0xf
    v_fmac_f32_dpp v228, v245, v196 quad_perm:[0,0,0,0] row_mask:0xf bank_mask:0xf
    v_fmac_f32_dpp v229, v245, v197 quad_perm:[0,0,0,0] row_mask:0xf bank_mask:0xf
    v_add_f32_dpp v226, v226, v226 row_ror:8 row_mask:0xf bank_mask:0xf
    v_fmac_f32_dpp v230, v245, v198 quad_perm:[0,0,0,0] row_mask:0xf bank_mask:0xf
    v_fmac_f32_dpp v231, v245, v249 quad_perm:[0,0,0,0] row_mask:0xf bank_mask:0xf
    v_mov_b32 v227, v226
    v_fmac_f32_dpp v228, v246, v200 quad_perm:[0,0,0,0] row_mask:0xf bank_mask:0xf
    v_fmac_f32_dpp v229, v246, v201 quad_perm:[0,0,0,0] row_mask:0xf bank_mask:0xf
    v_permlane16_swap_b32 v226, v227
    v_fmac_f32_dpp v230, v246, v202 quad_perm:[0,0,0,0] row_mask:0xf bank_mask:0xf
    v_fmac_f32_dpp v231, v246, v250 quad_perm:[0,0,0,0] row_mask:0xf bank_mask:0xf
    v_add_f32 v226, v226, v227
    v_fmac_f32_dpp v228, v247, v204 quad_perm:[0,0,0,0] row_mask:0xf bank_mask:0xf
    v_fmac_f32_dpp v229, v247, v205 quad_perm:[0,0,0,0] row_mask:0xf bank_mask:0xf
    v_mov_b32 v227, v226
    v_fmac_f32_dpp v230, v247, v206 quad_perm:[0,0,0,0] row_mask:0xf bank_mask:0xf
    v_fmac_f32_dpp v231, v247, v251 quad_perm:[0,0,0,0] row_mask:0xf bank_mask:0xf
    v_permlane32_swap_b32 v226, v227
    v_add_f32 v226, v226, v227
    v_permlane32_swap_b32 v228, v229
    v_permlane32_swap_b32 v230, v231
    v_rcp_f32 v226, v226
    v_add_f32 v228, v228, v229
    v_add_f32 v230, v230, v231
    s_nop 1
    v_permlane16_swap_b32 v228, v230
    v_add_f32 v228, v228, v230
    s_nop 1
    v_add_f32_dpp v228, v228, v228 row_ror:8 row_mask:0xf bank_mask:0xf
    v_mul_f32 v228, v228, v226
    v_cvt_pk_bf16_f32 v228, v228, v228
    s_nop 1
    v_mov_b32_dpp v232, v228 row_newbcast:0 row_mask:0xf bank_mask:0xf
    v_mov_b32_dpp v233, v228 row_newbcast:1 row_mask:0xf bank_mask:0xf
    v_mov_b32_dpp v234, v228 row_newbcast:2 row_mask:0xf bank_mask:0xf
    v_mov_b32_dpp v235, v228 row_newbcast:3 row_mask:0xf bank_mask:0xf
    v_mov_b32_dpp v236, v228 row_newbcast:4 row_mask:0xf bank_mask:0xf
    v_mov_b32_dpp v237, v228 row_newbcast:5 row_mask:0xf bank_mask:0xf
    v_mov_b32_dpp v238, v228 row_newbcast:6 row_mask:0xf bank_mask:0xf
    v_mov_b32_dpp v239, v228 row_newbcast:7 row_mask:0xf bank_mask:0xf
    v_perm_b32 v32, v232, v232, v8
    v_perm_b32 v33, v232, v232, v9
    v_perm_b32 v34, v232, v232, v10
    v_perm_b32 v35, v232, v232, v11
    s_nop 1
    v_mfma_f32_16x16x32_bf16 v[40:43], v[32:35], v[64:67], 0
    v_perm_b32 v36, v233, v233, v8
    v_perm_b32 v37, v233, v233, v9
    v_mfma_f32_16x16x32_bf16 v[44:47], v[32:35], v[68:71], 0
    v_perm_b32 v38, v233, v233, v10
    v_perm_b32 v39, v233, v233, v11
    v_mfma_f32_16x16x32_bf16 v[48:51], v[32:35], v[72:75], 0
    v_mfma_f32_16x16x32_bf16 v[52:55], v[32:35], v[76:79], 0
    v_mfma_f32_16x16x32_bf16 v[40:43], v[36:39], v[80:83], v[40:43]
    v_perm_b32 v32, v234, v234, v8
    v_perm_b32 v33, v234, v234, v9
    v_mfma_f32_16x16x32_bf16 v[44:47], v[36:39], v[84:87], v[44:47]
    v_perm_b32 v34, v234, v234, v10
    v_perm_b32 v35, v234, v234, v11
    v_mfma_f32_16x16x32_bf16 v[48:51], v[36:39], v[88:91], v[48:51]
    v_mfma_f32_16x16x32_bf16 v[52:55], v[36:39], v[92:95], v[52:55]
    v_mfma_f32_16x16x32_bf16 v[40:43], v[32:35], v[96:99], v[40:43]
    v_perm_b32 v36, v235, v235, v8
    v_perm_b32 v37, v235, v235, v9
    v_mfma_f32_16x16x32_bf16 v[44:47], v[32:35], v[100:103], v[44:47]
    v_perm_b32 v38, v235, v235, v10
    v_perm_b32 v39, v235, v235, v11
    v_mfma_f32_16x16x32_bf16 v[48:51], v[32:35], v[104:107], v[48:51]
    v_mfma_f32_16x16x32_bf16 v[52:55], v[32:35], v[108:111], v[52:55]
    v_mfma_f32_16x16x32_bf16 v[40:43], v[36:39], v[112:115], v[40:43]
    v_perm_b32 v32, v236, v236, v8
    v_perm_b32 v33, v236, v236, v9
    v_mfma_f32_16x16x32_bf16 v[44:47], v[36:39], v[116:119], v[44:47]
    v_perm_b32 v34, v236, v236, v10
    v_perm_b32 v35, v236, v236, v11
    v_mfma_f32_16x16x32_bf16 v[48:51], v[36:39], v[120:123], v[48:51]
    v_mfma_f32_16x16x32_bf16 v[52:55], v[36:39], v[124:127], v[52:55]
    v_mfma_f32_16x16x32_bf16 v[40:43], v[32:35], v[128:131], v[40:43]
    v_perm_b32 v36, v237, v237, v8
    v_perm_b32 v37, v237, v237, v9
    v_mfma_f32_16x16x32_bf16 v[44:47], v[32:35], v[132:135], v[44:47]
    v_perm_b32 v38, v237, v237, v10
    v_perm_b32 v39, v237, v237, v11
    v_mfma_f32_16x16x32_bf16 v[48:51], v[32:35], v[136:139], v[48:51]
    v_mfma_f32_16x16x32_bf16 v[52:55], v[32:35], v[140:143], v[52:55]
    v_mfma_f32_16x16x32_bf16 v[40:43], v[36:39], v[144:147], v[40:43]
    v_perm_b32 v32, v238, v238, v8
    v_perm_b32 v33, v238, v238, v9
    v_mfma_f32_16x16x32_bf16 v[44:47], v[36:39], v[148:151], v[44:47]
    v_perm_b32 v34, v238, v238, v10
    v_perm_b32 v35, v238, v238, v11
    v_mfma_f32_16x16x32_bf16 v[48:51], v[36:39], v[152:155], v[48:51]
    v_mfma_f32_16x16x32_bf16 v[52:55], v[36:39], v[156:159], v[52:55]
    v_mfma_f32_16x16x32_bf16 v[40:43], v[32:35], v[160:163], v[40:43]
    v_perm_b32 v36, v239, v239, v8
    v_perm_b32 v37, v239, v239, v9
    v_mfma_f32_16x16x32_bf16 v[44:47], v[32:35], v[164:167], v[44:47]
    v_perm_b32 v38, v239, v239, v10
    v_perm_b32 v39, v239, v239, v11
    v_mfma_f32_16x16x32_bf16 v[48:51], v[32:35], v[168:171], v[48:51]
    v_mfma_f32_16x16x32_bf16 v[52:55], v[32:35], v[172:175], v[52:55]
    v_mfma_f32_16x16x32_bf16 v[40:43], v[36:39], v[176:179], v[40:43]
    v_mfma_f32_16x16x32_bf16 v[44:47], v[36:39], v[180:183], v[44:47]
    v_mfma_f32_16x16x32_bf16 v[48:51], v[36:39], v[184:187], v[48:51]
    v_mfma_f32_16x16x32_bf16 v[52:55], v[36:39], v[188:191], v[52:55]
    v_lshrrev_b32 v227, 5, v0
    v_lshl_add_u32 v227, v227, 9, v59
    s_nop 3
    v_permlane32_swap_b32 v40, v44
    v_permlane32_swap_b32 v41, v45
    v_permlane32_swap_b32 v42, v46
    v_permlane32_swap_b32 v43, v47
    v_add_u32 v40, s8, v40
    v_add_u32 v41, s9, v41
    v_add_u32 v42, s10, v42
    v_add_u32 v43, s11, v43
    v_and_or_b32 v40, v40, v24, s4
    v_and_or_b32 v41, v41, v24, s5
    v_and_or_b32 v42, v42, v24, s6
    v_and_or_b32 v43, v43, v24, s7
    buffer_store_dwordx4 v[40:43], v227, s[36:39], s54 offen offset:0 sc1
    v_permlane32_swap_b32 v48, v52
    v_permlane32_swap_b32 v49, v53
    v_permlane32_swap_b32 v50, v54
    v_permlane32_swap_b32 v51, v55
    v_add_u32 v48, s8, v48
    v_add_u32 v49, s9, v49
    v_add_u32 v50, s10, v50
    v_add_u32 v51, s11, v51
    v_and_or_b32 v48, v48, v24, s4
    v_and_or_b32 v49, v49, v24, s5
    v_and_or_b32 v50, v50, v24, s6
    v_and_or_b32 v51, v51, v24, s7
    s_mov_b32 exec_hi, 0x00ff00ff
    buffer_store_dwordx4 v[48:51], v227, s[36:39], s54 offen offset:1024 sc1
    s_mov_b64 exec, -1
    s_cmp_ge_u32 s48, 28
    s_cbranch_scc1 L_he
    buffer_load_dwordx4 v[192:195], v63, s[36:39], s84 offen sc1
    buffer_load_dwordx4 v[196:199], v63, s[36:39], s85 offen sc1
    buffer_load_dwordx4 v[200:203], v63, s[36:39], s86 offen sc1
    buffer_load_dwordx4 v[204:207], v63, s[36:39], s87 offen sc1
    buffer_load_dwordx4 v[208:211], v63, s[36:39], s88 offen sc1
    buffer_load_dwordx4 v[212:215], v63, s[36:39], s89 offen sc1
    buffer_load_dwordx4 v[216:219], v63, s[36:39], s90 offen sc1
    buffer_load_dwordx4 v[220:223], v63, s[36:39], s91 offen sc1
    s_waitcnt vmcnt(0)
    s_mov_b32 s65, 1048576
L_yp:
    v_xor_b32 v25, s4, v192
    v_xor_b32 v26, s5, v193
    v_xor_b32 v27, s6, v194
    v_xor_b32 v28, s7, v195
    v_bitop3_b32 v25, v196, s4, v25 bitop3:0xbe
    v_bitop3_b32 v26, v197, s5, v26 bitop3:0xbe
    v_bitop3_b32 v27, v198, s6, v27 bitop3:0xbe
    v_bitop3_b32 v28, v199, s7, v28 bitop3:0xbe
    v_bitop3_b32 v25, v200, s4, v25 bitop3:0xbe
    v_bitop3_b32 v26, v201, s5, v26 bitop3:0xbe
    v_bitop3_b32 v27, v202, s6, v27 bitop3:0xbe
    v_bitop3_b32 v28, v203, s7, v28 bitop3:0xbe
    v_bitop3_b32 v25, v204, s4, v25 bitop3:0xbe
    v_bitop3_b32 v26, v205, s5, v26 bitop3:0xbe
    v_bitop3_b32 v27, v206, s6, v27 bitop3:0xbe
    v_bitop3_b32 v28, v207, s7, v28 bitop3:0xbe
    v_bitop3_b32 v25, v208, s4, v25 bitop3:0xbe
    v_bitop3_b32 v26, v209, s5, v26 bitop3:0xbe
    v_bitop3_b32 v27, v210, s6, v27 bitop3:0xbe
    v_bitop3_b32 v28, v211, s7, v28 bitop3:0xbe
    v_bitop3_b32 v25, v212, s4, v25 bitop3:0xbe
    v_bitop3_b32 v26, v213, s5, v26 bitop3:0xbe
    v_bitop3_b32 v27, v214, s6, v27 bitop3:0xbe
    v_bitop3_b32 v28, v215, s7, v28 bitop3:0xbe
    v_bitop3_b32 v25, v216, s4, v25 bitop3:0xbe
    v_bitop3_b32 v26, v217, s5, v26 bitop3:0xbe
    v_bitop3_b32 v27, v218, s6, v27 bitop3:0xbe
    v_bitop3_b32 v28, v219, s7, v28 bitop3:0xbe
    v_bitop3_b32 v25, v220, s4, v25 bitop3:0xbe
    v_bitop3_b32 v26, v221, s5, v26 bitop3:0xbe
    v_bitop3_b32 v27, v222, s6, v27 bitop3:0xbe
    v_bitop3_b32 v28, v223, s7, v28 bitop3:0xbe
    v_or_b32 v25, v25, v28
    v_or3_b32 v25, v25, v26, v27
    v_and_b32 v25, 0xfff, v25
    v_cmp_ne_u32 vcc, 0, v25
    s_cmp_lg_u64 vcc, 0
    s_nop 3
    s_cbranch_scc0 L_ypd
    s_mov_b64 exec, vcc
    buffer_load_dwordx4 v[192:195], v63, s[36:39], s84 offen sc1
    buffer_load_dwordx4 v[196:199], v63, s[36:39], s85 offen sc1
    buffer_load_dwordx4 v[200:203], v63, s[36:39], s86 offen sc1
    buffer_load_dwordx4 v[204:207], v63, s[36:39], s87 offen sc1
    buffer_load_dwordx4 v[208:211], v63, s[36:39], s88 offen sc1
    buffer_load_dwordx4 v[212:215], v63, s[36:39], s89 offen sc1
    buffer_load_dwordx4 v[216:219], v63, s[36:39], s90 offen sc1
    buffer_load_dwordx4 v[220:223], v63, s[36:39], s91 offen sc1
    s_mov_b64 exec, -1
    s_waitcnt vmcnt(48)
    s_sleep 1
    s_sub_u32 s65, s65, 1
    s_cmp_lg_u32 s65, 0
    s_cbranch_scc1 L_yp
L_ypd:
    v_pk_add_f32 v[224:225], v[192:193], v[208:209]
    v_pk_add_f32 v[226:227], v[194:195], v[210:211]
    v_pk_add_f32 v[228:229], v[196:197], v[212:213]
    v_pk_add_f32 v[230:231], v[198:199], v[214:215]
    v_pk_add_f32 v[232:233], v[200:201], v[216:217]
    v_pk_add_f32 v[234:235], v[202:203], v[218:219]
    v_pk_add_f32 v[236:237], v[204:205], v[220:221]
    v_pk_add_f32 v[238:239], v[206:207], v[222:223]
    v_pk_add_f32 v[224:225], v[224:225], v[232:233]
    v_pk_add_f32 v[226:227], v[226:227], v[234:235]
    v_pk_add_f32 v[228:229], v[228:229], v[236:237]
    v_pk_add_f32 v[230:231], v[230:231], v[238:239]
    v_pk_add_f32 v[224:225], v[224:225], v[228:229]
    v_pk_add_f32 v[226:227], v[226:227], v[230:231]
    s_nop 0
    v_permlane32_swap_b32 v224, v225
    v_permlane32_swap_b32 v226, v227
    v_add_f32 v224, v224, v225
    v_add_f32 v226, v226, v227
    s_nop 1
    v_permlane16_swap_b32 v224, v226
    v_add_f32 v224, v224, v226
    s_nop 1
    v_add_f32_dpp v224, v224, v224 row_ror:8 row_mask:0xf bank_mask:0xf
    s_nop 1
    v_add_f32_dpp v224, v224, v224 row_ror:4 row_mask:0xf bank_mask:0xf
    v_cvt_pk_bf16_f32 v224, v224, v224
    s_mov_b32 exec_lo, 0x000f000f
    s_mov_b32 exec_hi, 0x000f000f
    buffer_store_short v224, v1, s[40:43], s62 offen
    s_mov_b64 exec, -1
L_he:
    s_endpgm
L_stream:
    s_sub_u32 s31, s30, 1
    v_lshlrev_b32 v1, 9, v3
    v_lshl_add_u32 v1, v2, 4, v1
    s_mov_b32 s34, 0x1000000
    s_mov_b32 s35, 0x20000
    s_mov_b32 s42, 0x200000
    s_mov_b32 s43, 0x20000
    s_lshl_b32 s61, s31, 12
    s_lshl_b32 s49, s55, 15
    s_and_b32 s60, s48, 15
    s_lshl_b32 s60, s60, 20
    s_add_u32 s60, s60, s49
    s_lshl_b32 s64, s97, 24
    s_add_u32 s60, s60, s64
    s_waitcnt lgkmcnt(0)
    s_mov_b32 s36, s28
    s_mov_b32 s37, s29
    s_add_u32 s32, s6, s60
    s_addc_u32 s33, s7, 0
    s_add_u32 s40, s8, s60
    s_addc_u32 s41, s9, 0
    s_barrier
    s_mov_b32 s94, s61
    buffer_load_dwordx4 a[0:3], v1, s[40:43], s94 offen offset:0 nt
    buffer_load_dwordx4 a[4:7], v1, s[40:43], s94 offen offset:256 nt
    buffer_load_dwordx4 a[8:11], v1, s[40:43], s94 offen offset:2048 nt
    buffer_load_dwordx4 a[12:15], v1, s[40:43], s94 offen offset:2304 nt
    s_add_u32 s94, s94, 8192
    buffer_load_dwordx4 a[16:19], v1, s[40:43], s94 offen offset:0 nt
    buffer_load_dwordx4 a[20:23], v1, s[40:43], s94 offen offset:256 nt
    buffer_load_dwordx4 a[24:27], v1, s[40:43], s94 offen offset:2048 nt
    buffer_load_dwordx4 a[28:31], v1, s[40:43], s94 offen offset:2304 nt
    s_add_u32 s94, s94, 8192
    buffer_load_dwordx4 a[32:35], v1, s[40:43], s94 offen offset:0 nt
    buffer_load_dwordx4 a[36:39], v1, s[40:43], s94 offen offset:256 nt
    v_and_b32 v4, 1, v0
    v_cmp_eq_u32 vcc, 1, v4
    v_mov_b32 v5, 0x0c0c0100
    v_mov_b32 v6, 0x01000c0c
    v_cndmask_b32 v5, v5, v6, vcc
    v_mov_b32 v6, 0x0c0c0302
    v_mov_b32 v7, 0x03020c0c
    v_cndmask_b32 v6, v6, v7, vcc
    v_bfe_u32 v4, v0, 1, 2
    v_mov_b32 v7, 0x0c0c0c0c
    v_cmp_eq_u32 vcc, 0, v4
    s_nop 1
    v_cndmask_b32 v8, v7, v5, vcc
    v_cndmask_b32 v12, v7, v6, vcc
    v_cmp_eq_u32 vcc, 1, v4
    s_nop 1
    v_cndmask_b32 v9, v7, v5, vcc
    v_cndmask_b32 v13, v7, v6, vcc
    v_cmp_eq_u32 vcc, 2, v4
    s_nop 1
    v_cndmask_b32 v10, v7, v5, vcc
    v_cndmask_b32 v14, v7, v6, vcc
    v_cmp_eq_u32 vcc, 3, v4
    s_nop 1
    v_cndmask_b32 v11, v7, v5, vcc
    v_cndmask_b32 v15, v7, v6, vcc
    s_and_b32 s56, s2, 7
    s_lshl_b32 s56, s56, 21
    s_add_u32 s56, s56, s49
    s_add_u32 s56, s56, s61
    s_mov_b32 s57, 0
    s_mov_b32 s58, 0
    s_mov_b32 s59, 57
    s_mov_b32 s95, 0
    s_lshl_b32 s60, s96, 24
    s_add_u32 s80, s16, s60
    s_addc_u32 s81, s17, 0
    s_mov_b32 s82, 0x1000000
    s_mov_b32 s83, 0x20000
    s_add_u32 s84, s18, s60
    s_addc_u32 s85, s19, 0
    s_mov_b32 s86, 0x1000000
    s_mov_b32 s87, 0x20000
    s_lshl_b32 s91, s96, 8
    s_add_u32 s91, s91, 327680
    s_mov_b32 s62, 1035512379
    s_lshl_b32 s63, s31, 15
    s_add_u32 s63, s63, 9728
    v_add_u32 v62, 0x1000, v1
    s_waitcnt vmcnt(9)
    buffer_load_dwordx4 a[40:43], v1, s[40:43], s94 offen offset:2048 nt
    s_waitcnt vmcnt(9)
    buffer_load_dwordx4 a[44:47], v1, s[40:43], s94 offen offset:2304 nt
    s_add_u32 s94, s94, 8192
    s_waitcnt vmcnt(9)
    buffer_load_dwordx4 a[48:51], v1, s[40:43], s94 offen offset:0 nt
    s_waitcnt vmcnt(9)
    buffer_load_dwordx4 a[52:55], v1, s[40:43], s94 offen offset:256 nt
    s_waitcnt vmcnt(9)
    buffer_load_dwordx4 a[56:59], v1, s[40:43], s94 offen offset:2048 nt
    s_waitcnt vmcnt(9)
    buffer_load_dwordx4 a[60:63], v1, s[40:43], s94 offen offset:2304 nt
    s_add_u32 s94, s94, 40960
    s_waitcnt vmcnt(9)
    buffer_load_dwordx4 a[64:67], v1, s[40:43], s94 offen offset:0 nt
    s_waitcnt vmcnt(9)
    buffer_load_dwordx4 a[68:71], v1, s[40:43], s94 offen offset:256 nt
    s_waitcnt vmcnt(9)
    buffer_load_dwordx4 a[72:75], v1, s[40:43], s94 offen offset:2048 nt
    s_waitcnt vmcnt(9)
    buffer_load_dwordx4 a[76:79], v1, s[40:43], s94 offen offset:2304 nt
    s_add_u32 s94, s94, 8192
    s_waitcnt vmcnt(9)
    buffer_load_dwordx4 a[80:83], v1, s[40:43], s94 offen offset:0 nt
    s_waitcnt vmcnt(9)
    buffer_load_dwordx4 a[84:87], v1, s[40:43], s94 offen offset:256 nt
    s_waitcnt vmcnt(9)
    buffer_load_dwordx4 a[88:91], v1, s[40:43], s94 offen offset:2048 nt
    s_waitcnt vmcnt(9)
    buffer_load_dwordx4 a[92:95], v1, s[40:43], s94 offen offset:2304 nt
    s_add_u32 s94, s94, 8192
    s_waitcnt vmcnt(9)
    buffer_load_dwordx4 a[96:99], v1, s[40:43], s94 offen offset:0 nt
    s_waitcnt vmcnt(9)
    buffer_load_dwordx4 a[100:103], v1, s[40:43], s94 offen offset:256 nt
    s_waitcnt vmcnt(9)
    buffer_load_dwordx4 a[104:107], v1, s[40:43], s94 offen offset:2048 nt
    s_waitcnt vmcnt(9)
    buffer_load_dwordx4 a[108:111], v1, s[40:43], s94 offen offset:2304 nt
    s_add_u32 s94, s94, 8192
    s_waitcnt vmcnt(9)
    buffer_load_dwordx4 a[112:115], v1, s[40:43], s94 offen offset:0 nt
    s_waitcnt vmcnt(9)
    buffer_load_dwordx4 a[116:119], v1, s[40:43], s94 offen offset:256 nt
    s_waitcnt vmcnt(9)
    buffer_load_dwordx4 a[120:123], v1, s[40:43], s94 offen offset:2048 nt
    s_waitcnt vmcnt(9)
    buffer_load_dwordx4 a[124:127], v1, s[40:43], s94 offen offset:2304 nt
    s_add_u32 s94, s94, 40960
    s_waitcnt vmcnt(9)
    buffer_load_dwordx4 a[128:131], v1, s[40:43], s94 offen offset:0 nt
    s_waitcnt vmcnt(9)
    buffer_load_dwordx4 a[132:135], v1, s[40:43], s94 offen offset:256 nt
    s_waitcnt vmcnt(9)
    buffer_load_dwordx4 a[136:139], v1, s[40:43], s94 offen offset:2048 nt
    s_waitcnt vmcnt(9)
    buffer_load_dwordx4 a[140:143], v1, s[40:43], s94 offen offset:2304 nt
    s_add_u32 s94, s94, 8192
    s_waitcnt vmcnt(9)
    buffer_load_dwordx4 a[144:147], v1, s[40:43], s94 offen offset:0 nt
    s_waitcnt vmcnt(9)
    buffer_load_dwordx4 a[148:151], v1, s[40:43], s94 offen offset:256 nt
    s_waitcnt vmcnt(9)
    buffer_load_dwordx4 a[152:155], v1, s[40:43], s94 offen offset:2048 nt
    s_waitcnt vmcnt(9)
    buffer_load_dwordx4 a[156:159], v1, s[40:43], s94 offen offset:2304 nt
    s_add_u32 s94, s94, 8192
    s_waitcnt vmcnt(9)
    buffer_load_dwordx4 a[160:163], v1, s[40:43], s94 offen offset:0 nt
    s_waitcnt vmcnt(9)
    buffer_load_dwordx4 a[164:167], v1, s[40:43], s94 offen offset:256 nt
    s_waitcnt vmcnt(9)
    buffer_load_dwordx4 a[168:171], v1, s[40:43], s94 offen offset:2048 nt
    s_waitcnt vmcnt(9)
    buffer_load_dwordx4 a[172:175], v1, s[40:43], s94 offen offset:2304 nt
    s_add_u32 s94, s94, 8192
    s_waitcnt vmcnt(9)
    buffer_load_dwordx4 a[176:179], v1, s[40:43], s94 offen offset:0 nt
    s_waitcnt vmcnt(9)
    buffer_load_dwordx4 a[180:183], v1, s[40:43], s94 offen offset:256 nt
    s_waitcnt vmcnt(9)
    buffer_load_dwordx4 a[184:187], v1, s[40:43], s94 offen offset:2048 nt
    s_waitcnt vmcnt(9)
    buffer_load_dwordx4 a[188:191], v1, s[40:43], s94 offen offset:2304 nt
    s_add_u32 s94, s94, 40960
    s_mov_b32 s52, s61
    s_mov_b32 s53, 0
    s_waitcnt vmcnt(9)
    buffer_load_dwordx4 v[64:67], v1, s[32:35], s52 offen offset:0 nt
    s_waitcnt vmcnt(9)
    buffer_load_dwordx4 v[68:71], v1, s[32:35], s52 offen offset:256 nt
    s_waitcnt vmcnt(9)
    buffer_load_dwordx4 v[72:75], v1, s[32:35], s52 offen offset:2048 nt
    s_waitcnt vmcnt(9)
    buffer_load_dwordx4 v[76:79], v1, s[32:35], s52 offen offset:2304 nt
    s_add_u32 s52, s52, 8192
    s_waitcnt vmcnt(9)
    buffer_load_dwordx4 v[80:83], v1, s[32:35], s52 offen offset:0 nt
    s_waitcnt vmcnt(9)
    buffer_load_dwordx4 v[84:87], v1, s[32:35], s52 offen offset:256 nt
    s_waitcnt vmcnt(9)
    buffer_load_dwordx4 v[88:91], v1, s[32:35], s52 offen offset:2048 nt
    s_waitcnt vmcnt(9)
    buffer_load_dwordx4 v[92:95], v1, s[32:35], s52 offen offset:2304 nt
    s_add_u32 s52, s52, 8192
    s_waitcnt vmcnt(9)
    buffer_load_dwordx4 v[96:99], v1, s[32:35], s52 offen offset:0 nt
    s_waitcnt vmcnt(9)
    buffer_load_dwordx4 v[100:103], v1, s[32:35], s52 offen offset:256 nt
    s_barrier
    v_lshlrev_b32 v4, 2, v0
    v_add_u32 v4, s63, v4
    v_lshlrev_b32 v52, 4, v2
    ds_read_b128 v[16:19], v52 offset:0
    ds_read_b128 v[20:23], v52 offset:256
    ds_read_b128 v[24:27], v52 offset:512
    ds_read_b128 v[28:31], v52 offset:768
    v_mov_b32 v5, 0xff800000
    s_waitcnt lgkmcnt(0)
    s_mov_b32 s60, 16
L_ph0:
    s_waitcnt vmcnt(9)
    buffer_load_dwordx4 v[104:107], v1, s[32:35], s52 offen offset:2048 nt
    v_dot2_f32_bf16 v48, v64, v16, 0
    v_dot2_f32_bf16 v49, v64, v24, 0
    v_dot2_f32_bf16 v48, v65, v17, v48
    v_dot2_f32_bf16 v49, v65, v25, v49
    v_dot2_f32_bf16 v48, v66, v18, v48
    v_dot2_f32_bf16 v49, v66, v26, v49
    v_dot2_f32_bf16 v48, v67, v19, v48
    v_dot2_f32_bf16 v49, v67, v27, v49
    s_waitcnt vmcnt(9)
    buffer_load_dwordx4 v[108:111], v1, s[32:35], s52 offen offset:2304 nt
    s_add_u32 s52, s52, 8192
    v_dot2_f32_bf16 v48, v68, v20, v48
    v_dot2_f32_bf16 v49, v68, v28, v49
    v_dot2_f32_bf16 v48, v69, v21, v48
    v_dot2_f32_bf16 v49, v69, v29, v49
    v_dot2_f32_bf16 v48, v70, v22, v48
    v_dot2_f32_bf16 v49, v70, v30, v49
    v_dot2_f32_bf16 v48, v71, v23, v48
    v_dot2_f32_bf16 v49, v71, v31, v49
    s_waitcnt vmcnt(9)
    buffer_load_dwordx4 v[112:115], v1, s[32:35], s52 offen offset:0 nt
    v_dot2_f32_bf16 v50, v72, v16, 0
    v_dot2_f32_bf16 v51, v72, v24, 0
    v_dot2_f32_bf16 v50, v73, v17, v50
    v_dot2_f32_bf16 v51, v73, v25, v51
    v_dot2_f32_bf16 v50, v74, v18, v50
    v_dot2_f32_bf16 v51, v74, v26, v51
    v_dot2_f32_bf16 v50, v75, v19, v50
    v_dot2_f32_bf16 v51, v75, v27, v51
    s_waitcnt vmcnt(9)
    buffer_load_dwordx4 v[116:119], v1, s[32:35], s52 offen offset:256 nt
    v_dot2_f32_bf16 v50, v76, v20, v50
    v_dot2_f32_bf16 v51, v76, v28, v51
    v_dot2_f32_bf16 v50, v77, v21, v50
    v_dot2_f32_bf16 v51, v77, v29, v51
    v_dot2_f32_bf16 v50, v78, v22, v50
    v_dot2_f32_bf16 v51, v78, v30, v51
    v_dot2_f32_bf16 v50, v79, v23, v50
    v_dot2_f32_bf16 v51, v79, v31, v51
    v_add_f32_dpp v52, v48, v48 row_ror:8 row_mask:0xf bank_mask:0x3
    v_add_f32_dpp v52, v49, v49 row_ror:8 row_mask:0xf bank_mask:0xc
    v_add_f32_dpp v53, v50, v50 row_ror:8 row_mask:0xf bank_mask:0x3
    v_add_f32_dpp v53, v51, v51 row_ror:8 row_mask:0xf bank_mask:0xc
    v_add_f32_dpp v52, v52, v52 row_half_mirror row_mask:0xf bank_mask:0xf
    s_nop 0
    v_add_f32_dpp v53, v53, v53 row_half_mirror row_mask:0xf bank_mask:0xf
    v_add_f32_dpp v52, v52, v52 quad_perm:[1,0,3,2] row_mask:0xf bank_mask:0xf
    s_nop 0
    v_add_f32_dpp v53, v53, v53 quad_perm:[1,0,3,2] row_mask:0xf bank_mask:0xf
    v_add_f32_dpp v52, v52, v52 quad_perm:[2,3,0,1] row_mask:0xf bank_mask:0xf
    s_nop 0
    v_add_f32_dpp v53, v53, v53 quad_perm:[2,3,0,1] row_mask:0xf bank_mask:0xf
    v_max3_f32 v5, v5, v52, v53
    v_cvt_pk_bf16_f32 v54, v52, v53
    ds_write_b32 v4, v54 offset:0
    s_waitcnt vmcnt(9)
    buffer_load_dwordx4 v[120:123], v1, s[32:35], s52 offen offset:2048 nt
    v_dot2_f32_bf16 v48, v80, v16, 0
    v_dot2_f32_bf16 v49, v80, v24, 0
    v_dot2_f32_bf16 v48, v81, v17, v48
    v_dot2_f32_bf16 v49, v81, v25, v49
    v_dot2_f32_bf16 v48, v82, v18, v48
    v_dot2_f32_bf16 v49, v82, v26, v49
    v_dot2_f32_bf16 v48, v83, v19, v48
    v_dot2_f32_bf16 v49, v83, v27, v49
    s_waitcnt vmcnt(9)
    buffer_load_dwordx4 v[124:127], v1, s[32:35], s52 offen offset:2304 nt
    s_add_u32 s52, s52, 40960
    s_add_u32 s53, s53, 1
    s_cmp_eq_u32 s53, 16
    s_cselect_b32 s32, s40, s32
    s_cselect_b32 s33, s41, s33
    s_cselect_b32 s52, s94, s52
    v_dot2_f32_bf16 v48, v84, v20, v48
    v_dot2_f32_bf16 v49, v84, v28, v49
    v_dot2_f32_bf16 v48, v85, v21, v48
    v_dot2_f32_bf16 v49, v85, v29, v49
    v_dot2_f32_bf16 v48, v86, v22, v48
    v_dot2_f32_bf16 v49, v86, v30, v49
    v_dot2_f32_bf16 v48, v87, v23, v48
    v_dot2_f32_bf16 v49, v87, v31, v49
    s_waitcnt vmcnt(9)
    buffer_load_dwordx4 v[64:67], v1, s[32:35], s52 offen offset:0 nt
    v_dot2_f32_bf16 v50, v88, v16, 0
    v_dot2_f32_bf16 v51, v88, v24, 0
    v_dot2_f32_bf16 v50, v89, v17, v50
    v_dot2_f32_bf16 v51, v89, v25, v51
    v_dot2_f32_bf16 v50, v90, v18, v50
    v_dot2_f32_bf16 v51, v90, v26, v51
    v_dot2_f32_bf16 v50, v91, v19, v50
    v_dot2_f32_bf16 v51, v91, v27, v51
    s_waitcnt vmcnt(9)
    buffer_load_dwordx4 v[68:71], v1, s[32:35], s52 offen offset:256 nt
    v_dot2_f32_bf16 v50, v92, v20, v50
    v_dot2_f32_bf16 v51, v92, v28, v51
    v_dot2_f32_bf16 v50, v93, v21, v50
    v_dot2_f32_bf16 v51, v93, v29, v51
    v_dot2_f32_bf16 v50, v94, v22, v50
    v_dot2_f32_bf16 v51, v94, v30, v51
    v_dot2_f32_bf16 v50, v95, v23, v50
    v_dot2_f32_bf16 v51, v95, v31, v51
    v_add_f32_dpp v52, v48, v48 row_ror:8 row_mask:0xf bank_mask:0x3
    v_add_f32_dpp v52, v49, v49 row_ror:8 row_mask:0xf bank_mask:0xc
    v_add_f32_dpp v53, v50, v50 row_ror:8 row_mask:0xf bank_mask:0x3
    v_add_f32_dpp v53, v51, v51 row_ror:8 row_mask:0xf bank_mask:0xc
    v_add_f32_dpp v52, v52, v52 row_half_mirror row_mask:0xf bank_mask:0xf
    s_nop 0
    v_add_f32_dpp v53, v53, v53 row_half_mirror row_mask:0xf bank_mask:0xf
    v_add_f32_dpp v52, v52, v52 quad_perm:[1,0,3,2] row_mask:0xf bank_mask:0xf
    s_nop 0
    v_add_f32_dpp v53, v53, v53 quad_perm:[1,0,3,2] row_mask:0xf bank_mask:0xf
    v_add_f32_dpp v52, v52, v52 quad_perm:[2,3,0,1] row_mask:0xf bank_mask:0xf
    s_nop 0
    v_add_f32_dpp v53, v53, v53 quad_perm:[2,3,0,1] row_mask:0xf bank_mask:0xf
    v_max3_f32 v5, v5, v52, v53
    v_cvt_pk_bf16_f32 v54, v52, v53
    ds_write_b32 v4, v54 offset:256
    s_waitcnt vmcnt(9)
    buffer_load_dwordx4 v[72:75], v1, s[32:35], s52 offen offset:2048 nt
    v_dot2_f32_bf16 v48, v96, v16, 0
    v_dot2_f32_bf16 v49, v96, v24, 0
    v_dot2_f32_bf16 v48, v97, v17, v48
    v_dot2_f32_bf16 v49, v97, v25, v49
    v_dot2_f32_bf16 v48, v98, v18, v48
    v_dot2_f32_bf16 v49, v98, v26, v49
    v_dot2_f32_bf16 v48, v99, v19, v48
    v_dot2_f32_bf16 v49, v99, v27, v49
    s_waitcnt vmcnt(9)
    buffer_load_dwordx4 v[76:79], v1, s[32:35], s52 offen offset:2304 nt
    s_add_u32 s52, s52, 8192
    v_dot2_f32_bf16 v48, v100, v20, v48
    v_dot2_f32_bf16 v49, v100, v28, v49
    v_dot2_f32_bf16 v48, v101, v21, v48
    v_dot2_f32_bf16 v49, v101, v29, v49
    v_dot2_f32_bf16 v48, v102, v22, v48
    v_dot2_f32_bf16 v49, v102, v30, v49
    v_dot2_f32_bf16 v48, v103, v23, v48
    v_dot2_f32_bf16 v49, v103, v31, v49
    s_waitcnt vmcnt(9)
    buffer_load_dwordx4 v[80:83], v1, s[32:35], s52 offen offset:0 nt
    v_dot2_f32_bf16 v50, v104, v16, 0
    v_dot2_f32_bf16 v51, v104, v24, 0
    v_dot2_f32_bf16 v50, v105, v17, v50
    v_dot2_f32_bf16 v51, v105, v25, v51
    v_dot2_f32_bf16 v50, v106, v18, v50
    v_dot2_f32_bf16 v51, v106, v26, v51
    v_dot2_f32_bf16 v50, v107, v19, v50
    v_dot2_f32_bf16 v51, v107, v27, v51
    s_waitcnt vmcnt(9)
    buffer_load_dwordx4 v[84:87], v1, s[32:35], s52 offen offset:256 nt
    v_dot2_f32_bf16 v50, v108, v20, v50
    v_dot2_f32_bf16 v51, v108, v28, v51
    v_dot2_f32_bf16 v50, v109, v21, v50
    v_dot2_f32_bf16 v51, v109, v29, v51
    v_dot2_f32_bf16 v50, v110, v22, v50
    v_dot2_f32_bf16 v51, v110, v30, v51
    v_dot2_f32_bf16 v50, v111, v23, v50
    v_dot2_f32_bf16 v51, v111, v31, v51
    v_add_f32_dpp v52, v48, v48 row_ror:8 row_mask:0xf bank_mask:0x3
    v_add_f32_dpp v52, v49, v49 row_ror:8 row_mask:0xf bank_mask:0xc
    v_add_f32_dpp v53, v50, v50 row_ror:8 row_mask:0xf bank_mask:0x3
    v_add_f32_dpp v53, v51, v51 row_ror:8 row_mask:0xf bank_mask:0xc
    v_add_f32_dpp v52, v52, v52 row_half_mirror row_mask:0xf bank_mask:0xf
    s_nop 0
    v_add_f32_dpp v53, v53, v53 row_half_mirror row_mask:0xf bank_mask:0xf
    v_add_f32_dpp v52, v52, v52 quad_perm:[1,0,3,2] row_mask:0xf bank_mask:0xf
    s_nop 0
    v_add_f32_dpp v53, v53, v53 quad_perm:[1,0,3,2] row_mask:0xf bank_mask:0xf
    v_add_f32_dpp v52, v52, v52 quad_perm:[2,3,0,1] row_mask:0xf bank_mask:0xf
    s_nop 0
    v_add_f32_dpp v53, v53, v53 quad_perm:[2,3,0,1] row_mask:0xf bank_mask:0xf
    v_max3_f32 v5, v5, v52, v53
    v_cvt_pk_bf16_f32 v54, v52, v53
    ds_write_b32 v4, v54 offset:512
    s_waitcnt vmcnt(9)
    buffer_load_dwordx4 v[88:91], v1, s[32:35], s52 offen offset:2048 nt
    v_dot2_f32_bf16 v48, v112, v16, 0
    v_dot2_f32_bf16 v49, v112, v24, 0
    v_dot2_f32_bf16 v48, v113, v17, v48
    v_dot2_f32_bf16 v49, v113, v25, v49
    v_dot2_f32_bf16 v48, v114, v18, v48
    v_dot2_f32_bf16 v49, v114, v26, v49
    v_dot2_f32_bf16 v48, v115, v19, v48
    v_dot2_f32_bf16 v49, v115, v27, v49
    s_waitcnt vmcnt(9)
    buffer_load_dwordx4 v[92:95], v1, s[32:35], s52 offen offset:2304 nt
    s_add_u32 s52, s52, 8192
    v_dot2_f32_bf16 v48, v116, v20, v48
    v_dot2_f32_bf16 v49, v116, v28, v49
    v_dot2_f32_bf16 v48, v117, v21, v48
    v_dot2_f32_bf16 v49, v117, v29, v49
    v_dot2_f32_bf16 v48, v118, v22, v48
    v_dot2_f32_bf16 v49, v118, v30, v49
    v_dot2_f32_bf16 v48, v119, v23, v48
    v_dot2_f32_bf16 v49, v119, v31, v49
    s_waitcnt vmcnt(9)
    buffer_load_dwordx4 v[96:99], v1, s[32:35], s52 offen offset:0 nt
    v_dot2_f32_bf16 v50, v120, v16, 0
    v_dot2_f32_bf16 v51, v120, v24, 0
    v_dot2_f32_bf16 v50, v121, v17, v50
    v_dot2_f32_bf16 v51, v121, v25, v51
    v_dot2_f32_bf16 v50, v122, v18, v50
    v_dot2_f32_bf16 v51, v122, v26, v51
    v_dot2_f32_bf16 v50, v123, v19, v50
    v_dot2_f32_bf16 v51, v123, v27, v51
    s_waitcnt vmcnt(9)
    buffer_load_dwordx4 v[100:103], v1, s[32:35], s52 offen offset:256 nt
    v_dot2_f32_bf16 v50, v124, v20, v50
    v_dot2_f32_bf16 v51, v124, v28, v51
    v_dot2_f32_bf16 v50, v125, v21, v50
    v_dot2_f32_bf16 v51, v125, v29, v51
    v_dot2_f32_bf16 v50, v126, v22, v50
    v_dot2_f32_bf16 v51, v126, v30, v51
    v_dot2_f32_bf16 v50, v127, v23, v50
    v_dot2_f32_bf16 v51, v127, v31, v51
    v_add_f32_dpp v52, v48, v48 row_ror:8 row_mask:0xf bank_mask:0x3
    v_add_f32_dpp v52, v49, v49 row_ror:8 row_mask:0xf bank_mask:0xc
    v_add_f32_dpp v53, v50, v50 row_ror:8 row_mask:0xf bank_mask:0x3
    v_add_f32_dpp v53, v51, v51 row_ror:8 row_mask:0xf bank_mask:0xc
    v_add_f32_dpp v52, v52, v52 row_half_mirror row_mask:0xf bank_mask:0xf
    s_nop 0
    v_add_f32_dpp v53, v53, v53 row_half_mirror row_mask:0xf bank_mask:0xf
    v_add_f32_dpp v52, v52, v52 quad_perm:[1,0,3,2] row_mask:0xf bank_mask:0xf
    s_nop 0
    v_add_f32_dpp v53, v53, v53 quad_perm:[1,0,3,2] row_mask:0xf bank_mask:0xf
    v_add_f32_dpp v52, v52, v52 quad_perm:[2,3,0,1] row_mask:0xf bank_mask:0xf
    s_nop 0
    v_add_f32_dpp v53, v53, v53 quad_perm:[2,3,0,1] row_mask:0xf bank_mask:0xf
    v_max3_f32 v5, v5, v52, v53
    v_cvt_pk_bf16_f32 v54, v52, v53
    ds_write_b32 v4, v54 offset:768
    v_add_u32 v4, 1024, v4
    s_sub_u32 s60, s60, 1
    s_cmp_lg_u32 s60, 0
    s_cbranch_scc1 L_ph0
    v_lshlrev_b32 v4, 2, v0
    v_add_u32 v4, s63, v4
    ds_read_b32 v60, v4 offset:3072
    v_mov_b32 v59, v5
    s_nop 1
    v_permlane16_swap_b32 v5, v59
    v_max_f32 v5, v5, v59
    v_mov_b32 v59, v5
    s_nop 1
    v_permlane32_swap_b32 v5, v59
    v_max_f32 v5, v5, v59
    v_cvt_pk_bf16_f32 v5, v5, v5
    v_and_b32 v5, 0xffff0000, v5
    v_mul_f32 v7, s62, v5
    v_mov_b32 v6, 0
    v_mov_b32 v32, 0
    v_mov_b32 v33, 0
    v_mov_b32 v34, 0
    v_mov_b32 v35, 0
    v_mov_b32 v36, 0
    v_mov_b32 v37, 0
    v_mov_b32 v38, 0
    v_mov_b32 v39, 0
    v_mov_b32 v26, 1536
    v_mov_b32 v27, 1
    ds_read_b64 v[28:29], v26 offset:16
    v_lshrrev_b32 v24, 5, v0
    v_lshlrev_b32 v24, 14, v24
    v_lshrrev_b32 v25, 2, v2
    v_lshl_add_u32 v24, v25, 12, v24
    v_and_b32 v25, 3, v2
    v_lshl_add_u32 v24, v25, 5, v24
    v_and_b32 v25, 1, v3
    v_lshl_add_u32 v24, v25, 4, v24
    v_mov_b32 v31, 0xfffff000
    s_waitcnt lgkmcnt(0)
    v_lshlrev_b32 v52, 16, v60
    v_and_b32 v53, 0xffff0000, v60
    ds_read_b32 v61, v4 offset:0
    v_fma_f32 v52, v52, s62, -v7
    v_fma_f32 v53, v53, s62, -v7
    v_exp_f32 v52, v52
    v_exp_f32 v53, v53
    v_add_f32 v6, v6, v52
    v_add_f32 v6, v6, v53
    v_cvt_pk_bf16_f32 v52, v52, v53
    v_perm_b32 v40, v52, v52, v8
    v_perm_b32 v41, v52, v52, v9
    v_perm_b32 v42, v52, v52, v10
    v_perm_b32 v43, v52, v52, v11
    v_perm_b32 v44, v52, v52, v12
    v_perm_b32 v45, v52, v52, v13
    v_perm_b32 v46, v52, v52, v14
    v_perm_b32 v47, v52, v52, v15
    s_waitcnt vmcnt(9)
    buffer_load_dwordx4 v[104:107], v1, s[32:35], s52 offen offset:2048 nt
    v_mfma_f32_16x16x32_bf16 v[32:35], v[40:43], v[64:67], v[32:35]
    s_waitcnt vmcnt(9)
    buffer_load_dwordx4 v[108:111], v1, s[32:35], s52 offen offset:2304 nt
    s_add_u32 s52, s52, 8192
    v_mfma_f32_16x16x32_bf16 v[36:39], v[40:43], v[68:71], v[36:39]
    s_waitcnt vmcnt(9)
    buffer_load_dwordx4 v[112:115], v1, s[32:35], s52 offen offset:0 nt
    v_mfma_f32_16x16x32_bf16 v[32:35], v[44:47], v[72:75], v[32:35]
    s_waitcnt vmcnt(9)
    buffer_load_dwordx4 v[116:119], v1, s[32:35], s52 offen offset:256 nt
    v_mfma_f32_16x16x32_bf16 v[36:39], v[44:47], v[76:79], v[36:39]
    s_waitcnt lgkmcnt(0)
    v_lshlrev_b32 v52, 16, v61
    v_and_b32 v53, 0xffff0000, v61
    ds_read_b32 v60, v4 offset:3328
    v_fma_f32 v52, v52, s62, -v7
    v_fma_f32 v53, v53, s62, -v7
    v_exp_f32 v52, v52
    v_exp_f32 v53, v53
    v_add_f32 v6, v6, v52
    v_add_f32 v6, v6, v53
    v_cvt_pk_bf16_f32 v52, v52, v53
    v_perm_b32 v40, v52, v52, v8
    v_perm_b32 v41, v52, v52, v9
    v_perm_b32 v42, v52, v52, v10
    v_perm_b32 v43, v52, v52, v11
    v_perm_b32 v44, v52, v52, v12
    v_perm_b32 v45, v52, v52, v13
    v_perm_b32 v46, v52, v52, v14
    v_perm_b32 v47, v52, v52, v15
    v_mfma_f32_16x16x32_bf16 v[32:35], v[40:43], a[0:3], v[32:35]
    v_mfma_f32_16x16x32_bf16 v[36:39], v[40:43], a[4:7], v[36:39]
    v_mfma_f32_16x16x32_bf16 v[32:35], v[44:47], a[8:11], v[32:35]
    v_mfma_f32_16x16x32_bf16 v[36:39], v[44:47], a[12:15], v[36:39]
    s_waitcnt lgkmcnt(0)
    v_lshlrev_b32 v52, 16, v60
    v_and_b32 v53, 0xffff0000, v60
    ds_read_b32 v61, v4 offset:256
    v_fma_f32 v52, v52, s62, -v7
    v_fma_f32 v53, v53, s62, -v7
    v_exp_f32 v52, v52
    v_exp_f32 v53, v53
    v_add_f32 v6, v6, v52
    v_add_f32 v6, v6, v53
    v_cvt_pk_bf16_f32 v52, v52, v53
    v_perm_b32 v40, v52, v52, v8
    v_perm_b32 v41, v52, v52, v9
    v_perm_b32 v42, v52, v52, v10
    v_perm_b32 v43, v52, v52, v11
    v_perm_b32 v44, v52, v52, v12
    v_perm_b32 v45, v52, v52, v13
    v_perm_b32 v46, v52, v52, v14
    v_perm_b32 v47, v52, v52, v15
    s_waitcnt vmcnt(9)
    buffer_load_dwordx4 v[120:123], v1, s[32:35], s52 offen offset:2048 nt
    v_mfma_f32_16x16x32_bf16 v[32:35], v[40:43], v[80:83], v[32:35]
    s_waitcnt vmcnt(9)
    buffer_load_dwordx4 v[124:127], v1, s[32:35], s52 offen offset:2304 nt
    s_add_u32 s52, s52, 40960
    s_add_u32 s53, s53, 1
    s_cmp_eq_u32 s53, 29
    s_cselect_b32 s32, s80, s32
    s_cselect_b32 s33, s81, s33
    s_cselect_b32 s52, s56, s52
    v_mfma_f32_16x16x32_bf16 v[36:39], v[40:43], v[84:87], v[36:39]
    s_waitcnt vmcnt(9)
    buffer_load_dwordx4 v[64:67], v1, s[32:35], s52 offen offset:0 nt
    v_mfma_f32_16x16x32_bf16 v[32:35], v[44:47], v[88:91], v[32:35]
    s_waitcnt vmcnt(9)
    buffer_load_dwordx4 v[68:71], v1, s[32:35], s52 offen offset:256 nt
    v_mfma_f32_16x16x32_bf16 v[36:39], v[44:47], v[92:95], v[36:39]
    s_waitcnt lgkmcnt(0)
    v_lshlrev_b32 v52, 16, v61
    v_and_b32 v53, 0xffff0000, v61
    ds_read_b32 v60, v4 offset:3584
    v_fma_f32 v52, v52, s62, -v7
    v_fma_f32 v53, v53, s62, -v7
    v_exp_f32 v52, v52
    v_exp_f32 v53, v53
    v_add_f32 v6, v6, v52
    v_add_f32 v6, v6, v53
    v_cvt_pk_bf16_f32 v52, v52, v53
    v_perm_b32 v40, v52, v52, v8
    v_perm_b32 v41, v52, v52, v9
    v_perm_b32 v42, v52, v52, v10
    v_perm_b32 v43, v52, v52, v11
    v_perm_b32 v44, v52, v52, v12
    v_perm_b32 v45, v52, v52, v13
    v_perm_b32 v46, v52, v52, v14
    v_perm_b32 v47, v52, v52, v15
    v_mfma_f32_16x16x32_bf16 v[32:35], v[40:43], a[16:19], v[32:35]
    v_mfma_f32_16x16x32_bf16 v[36:39], v[40:43], a[20:23], v[36:39]
    v_mfma_f32_16x16x32_bf16 v[32:35], v[44:47], a[24:27], v[32:35]
    v_mfma_f32_16x16x32_bf16 v[36:39], v[44:47], a[28:31], v[36:39]
    s_waitcnt lgkmcnt(0)
    v_lshlrev_b32 v52, 16, v60
    v_and_b32 v53, 0xffff0000, v60
    ds_read_b32 v61, v4 offset:512
    v_fma_f32 v52, v52, s62, -v7
    v_fma_f32 v53, v53, s62, -v7
    v_exp_f32 v52, v52
    v_exp_f32 v53, v53
    v_add_f32 v6, v6, v52
    v_add_f32 v6, v6, v53
    v_cvt_pk_bf16_f32 v52, v52, v53
    v_perm_b32 v40, v52, v52, v8
    v_perm_b32 v41, v52, v52, v9
    v_perm_b32 v42, v52, v52, v10
    v_perm_b32 v43, v52, v52, v11
    v_perm_b32 v44, v52, v52, v12
    v_perm_b32 v45, v52, v52, v13
    v_perm_b32 v46, v52, v52, v14
    v_perm_b32 v47, v52, v52, v15
    s_waitcnt vmcnt(9)
    buffer_load_dwordx4 v[72:75], v1, s[32:35], s52 offen offset:2048 nt
    v_mfma_f32_16x16x32_bf16 v[32:35], v[40:43], v[96:99], v[32:35]
    s_waitcnt vmcnt(9)
    buffer_load_dwordx4 v[76:79], v1, s[32:35], s52 offen offset:2304 nt
    s_add_u32 s52, s52, 8192
    v_mfma_f32_16x16x32_bf16 v[36:39], v[40:43], v[100:103], v[36:39]
    s_waitcnt vmcnt(9)
    buffer_load_dwordx4 v[80:83], v1, s[32:35], s52 offen offset:0 nt
    v_mfma_f32_16x16x32_bf16 v[32:35], v[44:47], v[104:107], v[32:35]
    s_waitcnt vmcnt(9)
    buffer_load_dwordx4 v[84:87], v1, s[32:35], s52 offen offset:256 nt
    v_mfma_f32_16x16x32_bf16 v[36:39], v[44:47], v[108:111], v[36:39]
    s_waitcnt lgkmcnt(0)
    v_lshlrev_b32 v52, 16, v61
    v_and_b32 v53, 0xffff0000, v61
    ds_read_b32 v60, v4 offset:3840
    v_fma_f32 v52, v52, s62, -v7
    v_fma_f32 v53, v53, s62, -v7
    v_exp_f32 v52, v52
    v_exp_f32 v53, v53
    v_add_f32 v6, v6, v52
    v_add_f32 v6, v6, v53
    v_cvt_pk_bf16_f32 v52, v52, v53
    v_perm_b32 v40, v52, v52, v8
    v_perm_b32 v41, v52, v52, v9
    v_perm_b32 v42, v52, v52, v10
    v_perm_b32 v43, v52, v52, v11
    v_perm_b32 v44, v52, v52, v12
    v_perm_b32 v45, v52, v52, v13
    v_perm_b32 v46, v52, v52, v14
    v_perm_b32 v47, v52, v52, v15
    v_mfma_f32_16x16x32_bf16 v[32:35], v[40:43], a[32:35], v[32:35]
    v_mfma_f32_16x16x32_bf16 v[36:39], v[40:43], a[36:39], v[36:39]
    v_mfma_f32_16x16x32_bf16 v[32:35], v[44:47], a[40:43], v[32:35]
    v_mfma_f32_16x16x32_bf16 v[36:39], v[44:47], a[44:47], v[36:39]
    s_waitcnt lgkmcnt(0)
    v_lshlrev_b32 v52, 16, v60
    v_and_b32 v53, 0xffff0000, v60
    ds_read_b32 v61, v4 offset:768
    v_fma_f32 v52, v52, s62, -v7
    v_fma_f32 v53, v53, s62, -v7
    v_exp_f32 v52, v52
    v_exp_f32 v53, v53
    v_add_f32 v6, v6, v52
    v_add_f32 v6, v6, v53
    v_cvt_pk_bf16_f32 v52, v52, v53
    v_perm_b32 v40, v52, v52, v8
    v_perm_b32 v41, v52, v52, v9
    v_perm_b32 v42, v52, v52, v10
    v_perm_b32 v43, v52, v52, v11
    v_perm_b32 v44, v52, v52, v12
    v_perm_b32 v45, v52, v52, v13
    v_perm_b32 v46, v52, v52, v14
    v_perm_b32 v47, v52, v52, v15
    s_waitcnt vmcnt(9)
    buffer_load_dwordx4 v[88:91], v1, s[32:35], s52 offen offset:2048 nt
    v_mfma_f32_16x16x32_bf16 v[32:35], v[40:43], v[112:115], v[32:35]
    s_waitcnt vmcnt(9)
    buffer_load_dwordx4 v[92:95], v1, s[32:35], s52 offen offset:2304 nt
    s_add_u32 s52, s52, 8192
    v_mfma_f32_16x16x32_bf16 v[36:39], v[40:43], v[116:119], v[36:39]
    s_waitcnt vmcnt(9)
    buffer_load_dwordx4 v[96:99], v1, s[32:35], s52 offen offset:0 nt
    v_mfma_f32_16x16x32_bf16 v[32:35], v[44:47], v[120:123], v[32:35]
    s_waitcnt vmcnt(9)
    buffer_load_dwordx4 v[100:103], v1, s[32:35], s52 offen offset:256 nt
    v_mfma_f32_16x16x32_bf16 v[36:39], v[44:47], v[124:127], v[36:39]
    s_waitcnt lgkmcnt(0)
    v_lshlrev_b32 v52, 16, v61
    v_and_b32 v53, 0xffff0000, v61
    ds_read_b32 v60, v4 offset:4096
    v_fma_f32 v52, v52, s62, -v7
    v_fma_f32 v53, v53, s62, -v7
    v_exp_f32 v52, v52
    v_exp_f32 v53, v53
    v_add_f32 v6, v6, v52
    v_add_f32 v6, v6, v53
    v_cvt_pk_bf16_f32 v52, v52, v53
    v_perm_b32 v40, v52, v52, v8
    v_perm_b32 v41, v52, v52, v9
    v_perm_b32 v42, v52, v52, v10
    v_perm_b32 v43, v52, v52, v11
    v_perm_b32 v44, v52, v52, v12
    v_perm_b32 v45, v52, v52, v13
    v_perm_b32 v46, v52, v52, v14
    v_perm_b32 v47, v52, v52, v15
    v_mfma_f32_16x16x32_bf16 v[32:35], v[40:43], a[48:51], v[32:35]
    v_mfma_f32_16x16x32_bf16 v[36:39], v[40:43], a[52:55], v[36:39]
    v_mfma_f32_16x16x32_bf16 v[32:35], v[44:47], a[56:59], v[32:35]
    v_mfma_f32_16x16x32_bf16 v[36:39], v[44:47], a[60:63], v[36:39]
    s_waitcnt lgkmcnt(0)
    v_lshlrev_b32 v52, 16, v60
    v_and_b32 v53, 0xffff0000, v60
    ds_read_b32 v61, v4 offset:1024
    v_fma_f32 v52, v52, s62, -v7
    v_fma_f32 v53, v53, s62, -v7
    v_exp_f32 v52, v52
    v_exp_f32 v53, v53
    v_add_f32 v6, v6, v52
    v_add_f32 v6, v6, v53
    v_cvt_pk_bf16_f32 v52, v52, v53
    v_perm_b32 v40, v52, v52, v8
    v_perm_b32 v41, v52, v52, v9
    v_perm_b32 v42, v52, v52, v10
    v_perm_b32 v43, v52, v52, v11
    v_perm_b32 v44, v52, v52, v12
    v_perm_b32 v45, v52, v52, v13
    v_perm_b32 v46, v52, v52, v14
    v_perm_b32 v47, v52, v52, v15
    s_waitcnt vmcnt(9)
    buffer_load_dwordx4 v[104:107], v1, s[32:35], s52 offen offset:2048 nt
    v_mfma_f32_16x16x32_bf16 v[32:35], v[40:43], v[64:67], v[32:35]
    s_waitcnt vmcnt(9)
    buffer_load_dwordx4 v[108:111], v1, s[32:35], s52 offen offset:2304 nt
    s_add_u32 s52, s52, 8192
    v_mfma_f32_16x16x32_bf16 v[36:39], v[40:43], v[68:71], v[36:39]
    s_waitcnt vmcnt(9)
    buffer_load_dwordx4 v[112:115], v1, s[32:35], s52 offen offset:0 nt
    v_mfma_f32_16x16x32_bf16 v[32:35], v[44:47], v[72:75], v[32:35]
    s_waitcnt vmcnt(9)
    buffer_load_dwordx4 v[116:119], v1, s[32:35], s52 offen offset:256 nt
    v_mfma_f32_16x16x32_bf16 v[36:39], v[44:47], v[76:79], v[36:39]
    s_waitcnt lgkmcnt(0)
    v_lshlrev_b32 v52, 16, v61
    v_and_b32 v53, 0xffff0000, v61
    ds_read_b32 v60, v4 offset:4352
    v_fma_f32 v52, v52, s62, -v7
    v_fma_f32 v53, v53, s62, -v7
    v_exp_f32 v52, v52
    v_exp_f32 v53, v53
    v_add_f32 v6, v6, v52
    v_add_f32 v6, v6, v53
    v_cvt_pk_bf16_f32 v52, v52, v53
    v_perm_b32 v40, v52, v52, v8
    v_perm_b32 v41, v52, v52, v9
    v_perm_b32 v42, v52, v52, v10
    v_perm_b32 v43, v52, v52, v11
    v_perm_b32 v44, v52, v52, v12
    v_perm_b32 v45, v52, v52, v13
    v_perm_b32 v46, v52, v52, v14
    v_perm_b32 v47, v52, v52, v15
    v_mfma_f32_16x16x32_bf16 v[32:35], v[40:43], a[64:67], v[32:35]
    v_mfma_f32_16x16x32_bf16 v[36:39], v[40:43], a[68:71], v[36:39]
    v_mfma_f32_16x16x32_bf16 v[32:35], v[44:47], a[72:75], v[32:35]
    v_mfma_f32_16x16x32_bf16 v[36:39], v[44:47], a[76:79], v[36:39]
    s_waitcnt lgkmcnt(0)
    v_lshlrev_b32 v52, 16, v60
    v_and_b32 v53, 0xffff0000, v60
    ds_read_b32 v61, v4 offset:1280
    v_fma_f32 v52, v52, s62, -v7
    v_fma_f32 v53, v53, s62, -v7
    v_exp_f32 v52, v52
    v_exp_f32 v53, v53
    v_add_f32 v6, v6, v52
    v_add_f32 v6, v6, v53
    v_cvt_pk_bf16_f32 v52, v52, v53
    v_perm_b32 v40, v52, v52, v8
    v_perm_b32 v41, v52, v52, v9
    v_perm_b32 v42, v52, v52, v10
    v_perm_b32 v43, v52, v52, v11
    v_perm_b32 v44, v52, v52, v12
    v_perm_b32 v45, v52, v52, v13
    v_perm_b32 v46, v52, v52, v14
    v_perm_b32 v47, v52, v52, v15
    s_waitcnt vmcnt(9)
    buffer_load_dwordx4 v[120:123], v1, s[32:35], s52 offen offset:2048 nt
    v_mfma_f32_16x16x32_bf16 v[32:35], v[40:43], v[80:83], v[32:35]
    s_waitcnt vmcnt(9)
    buffer_load_dwordx4 v[124:127], v1, s[32:35], s52 offen offset:2304 nt
    s_add_u32 s52, s52, 40960
    s_add_u32 s53, s53, 1
    s_cmp_eq_u32 s53, 29
    s_cselect_b32 s32, s80, s32
    s_cselect_b32 s33, s81, s33
    s_cselect_b32 s52, s56, s52
    v_mfma_f32_16x16x32_bf16 v[36:39], v[40:43], v[84:87], v[36:39]
    s_waitcnt vmcnt(9)
    buffer_load_dwordx4 v[64:67], v1, s[32:35], s52 offen offset:0 nt
    v_mfma_f32_16x16x32_bf16 v[32:35], v[44:47], v[88:91], v[32:35]
    s_waitcnt vmcnt(9)
    buffer_load_dwordx4 v[68:71], v1, s[32:35], s52 offen offset:256 nt
    v_mfma_f32_16x16x32_bf16 v[36:39], v[44:47], v[92:95], v[36:39]
    s_waitcnt lgkmcnt(0)
    v_lshlrev_b32 v52, 16, v61
    v_and_b32 v53, 0xffff0000, v61
    ds_read_b32 v60, v4 offset:4608
    v_fma_f32 v52, v52, s62, -v7
    v_fma_f32 v53, v53, s62, -v7
    v_exp_f32 v52, v52
    v_exp_f32 v53, v53
    v_add_f32 v6, v6, v52
    v_add_f32 v6, v6, v53
    v_cvt_pk_bf16_f32 v52, v52, v53
    v_perm_b32 v40, v52, v52, v8
    v_perm_b32 v41, v52, v52, v9
    v_perm_b32 v42, v52, v52, v10
    v_perm_b32 v43, v52, v52, v11
    v_perm_b32 v44, v52, v52, v12
    v_perm_b32 v45, v52, v52, v13
    v_perm_b32 v46, v52, v52, v14
    v_perm_b32 v47, v52, v52, v15
    v_mfma_f32_16x16x32_bf16 v[32:35], v[40:43], a[80:83], v[32:35]
    v_mfma_f32_16x16x32_bf16 v[36:39], v[40:43], a[84:87], v[36:39]
    v_mfma_f32_16x16x32_bf16 v[32:35], v[44:47], a[88:91], v[32:35]
    v_mfma_f32_16x16x32_bf16 v[36:39], v[44:47], a[92:95], v[36:39]
    s_waitcnt lgkmcnt(0)
    v_lshlrev_b32 v52, 16, v60
    v_and_b32 v53, 0xffff0000, v60
    ds_read_b32 v61, v4 offset:1536
    v_fma_f32 v52, v52, s62, -v7
    v_fma_f32 v53, v53, s62, -v7
    v_exp_f32 v52, v52
    v_exp_f32 v53, v53
    v_add_f32 v6, v6, v52
    v_add_f32 v6, v6, v53
    v_cvt_pk_bf16_f32 v52, v52, v53
    v_perm_b32 v40, v52, v52, v8
    v_perm_b32 v41, v52, v52, v9
    v_perm_b32 v42, v52, v52, v10
    v_perm_b32 v43, v52, v52, v11
    v_perm_b32 v44, v52, v52, v12
    v_perm_b32 v45, v52, v52, v13
    v_perm_b32 v46, v52, v52, v14
    v_perm_b32 v47, v52, v52, v15
    s_waitcnt vmcnt(9)
    buffer_load_dwordx4 v[72:75], v1, s[32:35], s52 offen offset:2048 nt
    v_mfma_f32_16x16x32_bf16 v[32:35], v[40:43], v[96:99], v[32:35]
    s_waitcnt vmcnt(9)
    buffer_load_dwordx4 v[76:79], v1, s[32:35], s52 offen offset:2304 nt
    s_add_u32 s52, s52, 8192
    v_mfma_f32_16x16x32_bf16 v[36:39], v[40:43], v[100:103], v[36:39]
    s_waitcnt vmcnt(9)
    buffer_load_dwordx4 v[80:83], v1, s[32:35], s52 offen offset:0 nt
    v_mfma_f32_16x16x32_bf16 v[32:35], v[44:47], v[104:107], v[32:35]
    s_waitcnt vmcnt(9)
    buffer_load_dwordx4 v[84:87], v1, s[32:35], s52 offen offset:256 nt
    v_mfma_f32_16x16x32_bf16 v[36:39], v[44:47], v[108:111], v[36:39]
    s_waitcnt lgkmcnt(0)
    v_lshlrev_b32 v52, 16, v61
    v_and_b32 v53, 0xffff0000, v61
    ds_read_b32 v60, v4 offset:4864
    v_fma_f32 v52, v52, s62, -v7
    v_fma_f32 v53, v53, s62, -v7
    v_exp_f32 v52, v52
    v_exp_f32 v53, v53
    v_add_f32 v6, v6, v52
    v_add_f32 v6, v6, v53
    v_cvt_pk_bf16_f32 v52, v52, v53
    v_perm_b32 v40, v52, v52, v8
    v_perm_b32 v41, v52, v52, v9
    v_perm_b32 v42, v52, v52, v10
    v_perm_b32 v43, v52, v52, v11
    v_perm_b32 v44, v52, v52, v12
    v_perm_b32 v45, v52, v52, v13
    v_perm_b32 v46, v52, v52, v14
    v_perm_b32 v47, v52, v52, v15
    v_mfma_f32_16x16x32_bf16 v[32:35], v[40:43], a[96:99], v[32:35]
    v_mfma_f32_16x16x32_bf16 v[36:39], v[40:43], a[100:103], v[36:39]
    v_mfma_f32_16x16x32_bf16 v[32:35], v[44:47], a[104:107], v[32:35]
    v_mfma_f32_16x16x32_bf16 v[36:39], v[44:47], a[108:111], v[36:39]
    s_waitcnt lgkmcnt(0)
    v_lshlrev_b32 v52, 16, v60
    v_and_b32 v53, 0xffff0000, v60
    ds_read_b32 v61, v4 offset:1792
    v_fma_f32 v52, v52, s62, -v7
    v_fma_f32 v53, v53, s62, -v7
    v_exp_f32 v52, v52
    v_exp_f32 v53, v53
    v_add_f32 v6, v6, v52
    v_add_f32 v6, v6, v53
    v_cvt_pk_bf16_f32 v52, v52, v53
    v_perm_b32 v40, v52, v52, v8
    v_perm_b32 v41, v52, v52, v9
    v_perm_b32 v42, v52, v52, v10
    v_perm_b32 v43, v52, v52, v11
    v_perm_b32 v44, v52, v52, v12
    v_perm_b32 v45, v52, v52, v13
    v_perm_b32 v46, v52, v52, v14
    v_perm_b32 v47, v52, v52, v15
    s_waitcnt vmcnt(9)
    buffer_load_dwordx4 v[88:91], v1, s[32:35], s52 offen offset:2048 nt
    v_mfma_f32_16x16x32_bf16 v[32:35], v[40:43], v[112:115], v[32:35]
    s_waitcnt vmcnt(9)
    buffer_load_dwordx4 v[92:95], v1, s[32:35], s52 offen offset:2304 nt
    s_add_u32 s52, s52, 8192
    v_mfma_f32_16x16x32_bf16 v[36:39], v[40:43], v[116:119], v[36:39]
    s_waitcnt vmcnt(9)
    buffer_load_dwordx4 v[96:99], v1, s[32:35], s52 offen offset:0 nt
    v_mfma_f32_16x16x32_bf16 v[32:35], v[44:47], v[120:123], v[32:35]
    s_waitcnt vmcnt(9)
    buffer_load_dwordx4 v[100:103], v1, s[32:35], s52 offen offset:256 nt
    v_mfma_f32_16x16x32_bf16 v[36:39], v[44:47], v[124:127], v[36:39]
    s_waitcnt lgkmcnt(0)
    v_lshlrev_b32 v52, 16, v61
    v_and_b32 v53, 0xffff0000, v61
    ds_read_b32 v60, v4 offset:5120
    v_fma_f32 v52, v52, s62, -v7
    v_fma_f32 v53, v53, s62, -v7
    v_exp_f32 v52, v52
    v_exp_f32 v53, v53
    v_add_f32 v6, v6, v52
    v_add_f32 v6, v6, v53
    v_cvt_pk_bf16_f32 v52, v52, v53
    v_perm_b32 v40, v52, v52, v8
    v_perm_b32 v41, v52, v52, v9
    v_perm_b32 v42, v52, v52, v10
    v_perm_b32 v43, v52, v52, v11
    v_perm_b32 v44, v52, v52, v12
    v_perm_b32 v45, v52, v52, v13
    v_perm_b32 v46, v52, v52, v14
    v_perm_b32 v47, v52, v52, v15
    v_mfma_f32_16x16x32_bf16 v[32:35], v[40:43], a[112:115], v[32:35]
    v_mfma_f32_16x16x32_bf16 v[36:39], v[40:43], a[116:119], v[36:39]
    v_mfma_f32_16x16x32_bf16 v[32:35], v[44:47], a[120:123], v[32:35]
    v_mfma_f32_16x16x32_bf16 v[36:39], v[44:47], a[124:127], v[36:39]
    s_waitcnt lgkmcnt(0)
    v_lshlrev_b32 v52, 16, v60
    v_and_b32 v53, 0xffff0000, v60
    ds_read_b32 v61, v4 offset:2048
    v_fma_f32 v52, v52, s62, -v7
    v_fma_f32 v53, v53, s62, -v7
    v_exp_f32 v52, v52
    v_exp_f32 v53, v53
    v_add_f32 v6, v6, v52
    v_add_f32 v6, v6, v53
    v_cvt_pk_bf16_f32 v52, v52, v53
    v_perm_b32 v40, v52, v52, v8
    v_perm_b32 v41, v52, v52, v9
    v_perm_b32 v42, v52, v52, v10
    v_perm_b32 v43, v52, v52, v11
    v_perm_b32 v44, v52, v52, v12
    v_perm_b32 v45, v52, v52, v13
    v_perm_b32 v46, v52, v52, v14
    v_perm_b32 v47, v52, v52, v15
    s_waitcnt vmcnt(9)
    buffer_load_dwordx4 v[104:107], v1, s[32:35], s52 offen offset:2048 nt
    v_mfma_f32_16x16x32_bf16 v[32:35], v[40:43], v[64:67], v[32:35]
    s_waitcnt vmcnt(9)
    buffer_load_dwordx4 v[108:111], v1, s[32:35], s52 offen offset:2304 nt
    s_add_u32 s52, s52, 8192
    v_mfma_f32_16x16x32_bf16 v[36:39], v[40:43], v[68:71], v[36:39]
    s_waitcnt vmcnt(9)
    buffer_load_dwordx4 v[112:115], v1, s[32:35], s52 offen offset:0 nt
    v_mfma_f32_16x16x32_bf16 v[32:35], v[44:47], v[72:75], v[32:35]
    s_waitcnt vmcnt(9)
    buffer_load_dwordx4 v[116:119], v1, s[32:35], s52 offen offset:256 nt
    v_mfma_f32_16x16x32_bf16 v[36:39], v[44:47], v[76:79], v[36:39]
    s_waitcnt lgkmcnt(0)
    v_lshlrev_b32 v52, 16, v61
    v_and_b32 v53, 0xffff0000, v61
    ds_read_b32 v60, v4 offset:5376
    v_fma_f32 v52, v52, s62, -v7
    v_fma_f32 v53, v53, s62, -v7
    v_exp_f32 v52, v52
    v_exp_f32 v53, v53
    v_add_f32 v6, v6, v52
    v_add_f32 v6, v6, v53
    v_cvt_pk_bf16_f32 v52, v52, v53
    v_perm_b32 v40, v52, v52, v8
    v_perm_b32 v41, v52, v52, v9
    v_perm_b32 v42, v52, v52, v10
    v_perm_b32 v43, v52, v52, v11
    v_perm_b32 v44, v52, v52, v12
    v_perm_b32 v45, v52, v52, v13
    v_perm_b32 v46, v52, v52, v14
    v_perm_b32 v47, v52, v52, v15
    v_mfma_f32_16x16x32_bf16 v[32:35], v[40:43], a[128:131], v[32:35]
    v_mfma_f32_16x16x32_bf16 v[36:39], v[40:43], a[132:135], v[36:39]
    v_mfma_f32_16x16x32_bf16 v[32:35], v[44:47], a[136:139], v[32:35]
    v_mfma_f32_16x16x32_bf16 v[36:39], v[44:47], a[140:143], v[36:39]
    s_waitcnt lgkmcnt(0)
    v_lshlrev_b32 v52, 16, v60
    v_and_b32 v53, 0xffff0000, v60
    ds_read_b32 v61, v4 offset:2304
    v_fma_f32 v52, v52, s62, -v7
    v_fma_f32 v53, v53, s62, -v7
    v_exp_f32 v52, v52
    v_exp_f32 v53, v53
    v_add_f32 v6, v6, v52
    v_add_f32 v6, v6, v53
    v_cvt_pk_bf16_f32 v52, v52, v53
    v_perm_b32 v40, v52, v52, v8
    v_perm_b32 v41, v52, v52, v9
    v_perm_b32 v42, v52, v52, v10
    v_perm_b32 v43, v52, v52, v11
    v_perm_b32 v44, v52, v52, v12
    v_perm_b32 v45, v52, v52, v13
    v_perm_b32 v46, v52, v52, v14
    v_perm_b32 v47, v52, v52, v15
    s_waitcnt vmcnt(9)
    buffer_load_dwordx4 v[120:123], v1, s[32:35], s52 offen offset:2048 nt
    v_mfma_f32_16x16x32_bf16 v[32:35], v[40:43], v[80:83], v[32:35]
    s_waitcnt vmcnt(9)
    buffer_load_dwordx4 v[124:127], v1, s[32:35], s52 offen offset:2304 nt
    s_add_u32 s52, s52, 40960
    s_add_u32 s53, s53, 1
    s_cmp_eq_u32 s53, 29
    s_cselect_b32 s32, s80, s32
    s_cselect_b32 s33, s81, s33
    s_cselect_b32 s52, s56, s52
    v_mfma_f32_16x16x32_bf16 v[36:39], v[40:43], v[84:87], v[36:39]
    s_waitcnt vmcnt(9)
    buffer_load_dwordx4 v[64:67], v1, s[32:35], s52 offen offset:0 nt
    v_mfma_f32_16x16x32_bf16 v[32:35], v[44:47], v[88:91], v[32:35]
    s_waitcnt vmcnt(9)
    buffer_load_dwordx4 v[68:71], v1, s[32:35], s52 offen offset:256 nt
    v_mfma_f32_16x16x32_bf16 v[36:39], v[44:47], v[92:95], v[36:39]
    s_waitcnt lgkmcnt(0)
    v_lshlrev_b32 v52, 16, v61
    v_and_b32 v53, 0xffff0000, v61
    ds_read_b32 v60, v4 offset:5632
    v_fma_f32 v52, v52, s62, -v7
    v_fma_f32 v53, v53, s62, -v7
    v_exp_f32 v52, v52
    v_exp_f32 v53, v53
    v_add_f32 v6, v6, v52
    v_add_f32 v6, v6, v53
    v_cvt_pk_bf16_f32 v52, v52, v53
    v_perm_b32 v40, v52, v52, v8
    v_perm_b32 v41, v52, v52, v9
    v_perm_b32 v42, v52, v52, v10
    v_perm_b32 v43, v52, v52, v11
    v_perm_b32 v44, v52, v52, v12
    v_perm_b32 v45, v52, v52, v13
    v_perm_b32 v46, v52, v52, v14
    v_perm_b32 v47, v52, v52, v15
    v_mfma_f32_16x16x32_bf16 v[32:35], v[40:43], a[144:147], v[32:35]
    v_mfma_f32_16x16x32_bf16 v[36:39], v[40:43], a[148:151], v[36:39]
    v_mfma_f32_16x16x32_bf16 v[32:35], v[44:47], a[152:155], v[32:35]
    v_mfma_f32_16x16x32_bf16 v[36:39], v[44:47], a[156:159], v[36:39]
    s_waitcnt lgkmcnt(0)
    v_lshlrev_b32 v52, 16, v60
    v_and_b32 v53, 0xffff0000, v60
    ds_read_b32 v61, v4 offset:2560
    v_fma_f32 v52, v52, s62, -v7
    v_fma_f32 v53, v53, s62, -v7
    v_exp_f32 v52, v52
    v_exp_f32 v53, v53
    v_add_f32 v6, v6, v52
    v_add_f32 v6, v6, v53
    v_cvt_pk_bf16_f32 v52, v52, v53
    v_perm_b32 v40, v52, v52, v8
    v_perm_b32 v41, v52, v52, v9
    v_perm_b32 v42, v52, v52, v10
    v_perm_b32 v43, v52, v52, v11
    v_perm_b32 v44, v52, v52, v12
    v_perm_b32 v45, v52, v52, v13
    v_perm_b32 v46, v52, v52, v14
    v_perm_b32 v47, v52, v52, v15
    s_waitcnt vmcnt(9)
    buffer_load_dwordx4 v[72:75], v1, s[32:35], s52 offen offset:2048 nt
    v_mfma_f32_16x16x32_bf16 v[32:35], v[40:43], v[96:99], v[32:35]
    s_waitcnt vmcnt(9)
    buffer_load_dwordx4 v[76:79], v1, s[32:35], s52 offen offset:2304 nt
    s_add_u32 s52, s52, 8192
    v_mfma_f32_16x16x32_bf16 v[36:39], v[40:43], v[100:103], v[36:39]
    s_waitcnt vmcnt(9)
    buffer_load_dwordx4 v[80:83], v1, s[32:35], s52 offen offset:0 nt
    v_mfma_f32_16x16x32_bf16 v[32:35], v[44:47], v[104:107], v[32:35]
    s_waitcnt vmcnt(9)
    buffer_load_dwordx4 v[84:87], v1, s[32:35], s52 offen offset:256 nt
    v_mfma_f32_16x16x32_bf16 v[36:39], v[44:47], v[108:111], v[36:39]
    s_waitcnt lgkmcnt(0)
    v_lshlrev_b32 v52, 16, v61
    v_and_b32 v53, 0xffff0000, v61
    ds_read_b32 v60, v4 offset:5888
    v_fma_f32 v52, v52, s62, -v7
    v_fma_f32 v53, v53, s62, -v7
    v_exp_f32 v52, v52
    v_exp_f32 v53, v53
    v_add_f32 v6, v6, v52
    v_add_f32 v6, v6, v53
    v_cvt_pk_bf16_f32 v52, v52, v53
    v_perm_b32 v40, v52, v52, v8
    v_perm_b32 v41, v52, v52, v9
    v_perm_b32 v42, v52, v52, v10
    v_perm_b32 v43, v52, v52, v11
    v_perm_b32 v44, v52, v52, v12
    v_perm_b32 v45, v52, v52, v13
    v_perm_b32 v46, v52, v52, v14
    v_perm_b32 v47, v52, v52, v15
    v_mfma_f32_16x16x32_bf16 v[32:35], v[40:43], a[160:163], v[32:35]
    v_mfma_f32_16x16x32_bf16 v[36:39], v[40:43], a[164:167], v[36:39]
    v_mfma_f32_16x16x32_bf16 v[32:35], v[44:47], a[168:171], v[32:35]
    v_mfma_f32_16x16x32_bf16 v[36:39], v[44:47], a[172:175], v[36:39]
    s_waitcnt lgkmcnt(0)
    v_lshlrev_b32 v52, 16, v60
    v_and_b32 v53, 0xffff0000, v60
    ds_read_b32 v61, v4 offset:2816
    v_fma_f32 v52, v52, s62, -v7
    v_fma_f32 v53, v53, s62, -v7
    v_exp_f32 v52, v52
    v_exp_f32 v53, v53
    v_add_f32 v6, v6, v52
    v_add_f32 v6, v6, v53
    v_cvt_pk_bf16_f32 v52, v52, v53
    v_perm_b32 v40, v52, v52, v8
    v_perm_b32 v41, v52, v52, v9
    v_perm_b32 v42, v52, v52, v10
    v_perm_b32 v43, v52, v52, v11
    v_perm_b32 v44, v52, v52, v12
    v_perm_b32 v45, v52, v52, v13
    v_perm_b32 v46, v52, v52, v14
    v_perm_b32 v47, v52, v52, v15
    s_waitcnt vmcnt(9)
    buffer_load_dwordx4 v[88:91], v1, s[32:35], s52 offen offset:2048 nt
    v_mfma_f32_16x16x32_bf16 v[32:35], v[40:43], v[112:115], v[32:35]
    s_waitcnt vmcnt(9)
    buffer_load_dwordx4 v[92:95], v1, s[32:35], s52 offen offset:2304 nt
    s_add_u32 s52, s52, 8192
    v_mfma_f32_16x16x32_bf16 v[36:39], v[40:43], v[116:119], v[36:39]
    s_waitcnt vmcnt(9)
    buffer_load_dwordx4 v[96:99], v1, s[32:35], s52 offen offset:0 nt
    v_mfma_f32_16x16x32_bf16 v[32:35], v[44:47], v[120:123], v[32:35]
    s_waitcnt vmcnt(9)
    buffer_load_dwordx4 v[100:103], v1, s[32:35], s52 offen offset:256 nt
    v_mfma_f32_16x16x32_bf16 v[36:39], v[44:47], v[124:127], v[36:39]
    s_waitcnt lgkmcnt(0)
    v_lshlrev_b32 v52, 16, v61
    v_and_b32 v53, 0xffff0000, v61
    ds_read_b32 v60, v4 offset:6144
    v_fma_f32 v52, v52, s62, -v7
    v_fma_f32 v53, v53, s62, -v7
    v_exp_f32 v52, v52
    v_exp_f32 v53, v53
    v_add_f32 v6, v6, v52
    v_add_f32 v6, v6, v53
    v_cvt_pk_bf16_f32 v52, v52, v53
    v_perm_b32 v40, v52, v52, v8
    v_perm_b32 v41, v52, v52, v9
    v_perm_b32 v42, v52, v52, v10
    v_perm_b32 v43, v52, v52, v11
    v_perm_b32 v44, v52, v52, v12
    v_perm_b32 v45, v52, v52, v13
    v_perm_b32 v46, v52, v52, v14
    v_perm_b32 v47, v52, v52, v15
    v_mfma_f32_16x16x32_bf16 v[32:35], v[40:43], a[176:179], v[32:35]
    v_mfma_f32_16x16x32_bf16 v[36:39], v[40:43], a[180:183], v[36:39]
    v_mfma_f32_16x16x32_bf16 v[32:35], v[44:47], a[184:187], v[32:35]
    v_mfma_f32_16x16x32_bf16 v[36:39], v[44:47], a[188:191], v[36:39]
    v_add_u32 v4, 6144, v4
    s_mov_b32 s60, 10
    s_nop 5
L_ph1:
    s_waitcnt lgkmcnt(0)
    v_lshlrev_b32 v52, 16, v60
    v_and_b32 v53, 0xffff0000, v60
    ds_read_b32 v61, v4 offset:256
    v_fma_f32 v52, v52, s62, -v7
    v_fma_f32 v53, v53, s62, -v7
    v_exp_f32 v52, v52
    v_exp_f32 v53, v53
    v_add_f32 v6, v6, v52
    v_add_f32 v6, v6, v53
    v_cvt_pk_bf16_f32 v52, v52, v53
    v_perm_b32 v40, v52, v52, v8
    v_perm_b32 v41, v52, v52, v9
    v_perm_b32 v42, v52, v52, v10
    v_perm_b32 v43, v52, v52, v11
    v_perm_b32 v44, v52, v52, v12
    v_perm_b32 v45, v52, v52, v13
    v_perm_b32 v46, v52, v52, v14
    v_perm_b32 v47, v52, v52, v15
    s_waitcnt vmcnt(9)
    buffer_load_dwordx4 v[104:107], v1, s[32:35], s52 offen offset:2048 nt
    v_mfma_f32_16x16x32_bf16 v[32:35], v[40:43], v[64:67], v[32:35]
    s_waitcnt vmcnt(9)
    buffer_load_dwordx4 v[108:111], v1, s[32:35], s52 offen offset:2304 nt
    s_add_u32 s52, s52, 8192
    v_mfma_f32_16x16x32_bf16 v[36:39], v[40:43], v[68:71], v[36:39]
    s_waitcnt vmcnt(9)
    buffer_load_dwordx4 v[112:115], v1, s[32:35], s52 offen offset:0 nt
    v_mfma_f32_16x16x32_bf16 v[32:35], v[44:47], v[72:75], v[32:35]
    s_waitcnt vmcnt(9)
    buffer_load_dwordx4 v[116:119], v1, s[32:35], s52 offen offset:256 nt
    v_mfma_f32_16x16x32_bf16 v[36:39], v[44:47], v[76:79], v[36:39]
    s_waitcnt lgkmcnt(0)
    v_lshlrev_b32 v52, 16, v61
    v_and_b32 v53, 0xffff0000, v61
    ds_read_b32 v60, v4 offset:512
    v_fma_f32 v52, v52, s62, -v7
    v_fma_f32 v53, v53, s62, -v7
    v_exp_f32 v52, v52
    v_exp_f32 v53, v53
    v_add_f32 v6, v6, v52
    v_add_f32 v6, v6, v53
    v_cvt_pk_bf16_f32 v52, v52, v53
    v_perm_b32 v40, v52, v52, v8
    v_perm_b32 v41, v52, v52, v9
    v_perm_b32 v42, v52, v52, v10
    v_perm_b32 v43, v52, v52, v11
    v_perm_b32 v44, v52, v52, v12
    v_perm_b32 v45, v52, v52, v13
    v_perm_b32 v46, v52, v52, v14
    v_perm_b32 v47, v52, v52, v15
    s_waitcnt vmcnt(9)
    buffer_load_dwordx4 v[120:123], v1, s[32:35], s52 offen offset:2048 nt
    v_mfma_f32_16x16x32_bf16 v[32:35], v[40:43], v[80:83], v[32:35]
    s_waitcnt vmcnt(9)
    buffer_load_dwordx4 v[124:127], v1, s[32:35], s52 offen offset:2304 nt
    s_add_u32 s52, s52, 40960
    s_add_u32 s53, s53, 1
    s_cmp_eq_u32 s53, 29
    s_cselect_b32 s32, s80, s32
    s_cselect_b32 s33, s81, s33
    s_cselect_b32 s52, s56, s52
    v_mfma_f32_16x16x32_bf16 v[36:39], v[40:43], v[84:87], v[36:39]
    s_waitcnt vmcnt(9)
    buffer_load_dwordx4 v[64:67], v1, s[32:35], s52 offen offset:0 nt
    v_mfma_f32_16x16x32_bf16 v[32:35], v[44:47], v[88:91], v[32:35]
    s_waitcnt vmcnt(9)
    buffer_load_dwordx4 v[68:71], v1, s[32:35], s52 offen offset:256 nt
    v_mfma_f32_16x16x32_bf16 v[36:39], v[44:47], v[92:95], v[36:39]
    s_waitcnt lgkmcnt(0)
    v_lshlrev_b32 v52, 16, v60
    v_and_b32 v53, 0xffff0000, v60
    ds_read_b32 v61, v4 offset:768
    v_fma_f32 v52, v52, s62, -v7
    v_fma_f32 v53, v53, s62, -v7
    v_exp_f32 v52, v52
    v_exp_f32 v53, v53
    v_add_f32 v6, v6, v52
    v_add_f32 v6, v6, v53
    v_cvt_pk_bf16_f32 v52, v52, v53
    v_perm_b32 v40, v52, v52, v8
    v_perm_b32 v41, v52, v52, v9
    v_perm_b32 v42, v52, v52, v10
    v_perm_b32 v43, v52, v52, v11
    v_perm_b32 v44, v52, v52, v12
    v_perm_b32 v45, v52, v52, v13
    v_perm_b32 v46, v52, v52, v14
    v_perm_b32 v47, v52, v52, v15
    s_waitcnt vmcnt(9)
    buffer_load_dwordx4 v[72:75], v1, s[32:35], s52 offen offset:2048 nt
    v_mfma_f32_16x16x32_bf16 v[32:35], v[40:43], v[96:99], v[32:35]
    s_waitcnt vmcnt(9)
    buffer_load_dwordx4 v[76:79], v1, s[32:35], s52 offen offset:2304 nt
    s_add_u32 s52, s52, 8192
    v_mfma_f32_16x16x32_bf16 v[36:39], v[40:43], v[100:103], v[36:39]
    s_waitcnt vmcnt(9)
    buffer_load_dwordx4 v[80:83], v1, s[32:35], s52 offen offset:0 nt
    v_mfma_f32_16x16x32_bf16 v[32:35], v[44:47], v[104:107], v[32:35]
    s_waitcnt vmcnt(9)
    buffer_load_dwordx4 v[84:87], v1, s[32:35], s52 offen offset:256 nt
    v_mfma_f32_16x16x32_bf16 v[36:39], v[44:47], v[108:111], v[36:39]
    s_waitcnt lgkmcnt(0)
    v_lshlrev_b32 v52, 16, v61
    v_and_b32 v53, 0xffff0000, v61
    ds_read_b32 v60, v4 offset:1024
    v_fma_f32 v52, v52, s62, -v7
    v_fma_f32 v53, v53, s62, -v7
    v_exp_f32 v52, v52
    v_exp_f32 v53, v53
    v_add_f32 v6, v6, v52
    v_add_f32 v6, v6, v53
    v_cvt_pk_bf16_f32 v52, v52, v53
    v_perm_b32 v40, v52, v52, v8
    v_perm_b32 v41, v52, v52, v9
    v_perm_b32 v42, v52, v52, v10
    v_perm_b32 v43, v52, v52, v11
    v_perm_b32 v44, v52, v52, v12
    v_perm_b32 v45, v52, v52, v13
    v_perm_b32 v46, v52, v52, v14
    v_perm_b32 v47, v52, v52, v15
    s_waitcnt vmcnt(9)
    buffer_load_dwordx4 v[88:91], v1, s[32:35], s52 offen offset:2048 nt
    v_mfma_f32_16x16x32_bf16 v[32:35], v[40:43], v[112:115], v[32:35]
    s_waitcnt vmcnt(9)
    buffer_load_dwordx4 v[92:95], v1, s[32:35], s52 offen offset:2304 nt
    s_add_u32 s52, s52, 8192
    v_mfma_f32_16x16x32_bf16 v[36:39], v[40:43], v[116:119], v[36:39]
    s_waitcnt vmcnt(9)
    buffer_load_dwordx4 v[96:99], v1, s[32:35], s52 offen offset:0 nt
    v_mfma_f32_16x16x32_bf16 v[32:35], v[44:47], v[120:123], v[32:35]
    s_waitcnt vmcnt(9)
    buffer_load_dwordx4 v[100:103], v1, s[32:35], s52 offen offset:256 nt
    v_mfma_f32_16x16x32_bf16 v[36:39], v[44:47], v[124:127], v[36:39]
    v_add_u32 v4, 1024, v4
    s_sub_u32 s60, s60, 1
    s_cmp_lg_u32 s60, 0
    s_nop 4
    s_cbranch_scc1 L_ph1
    v_mov_b32 v59, v6
    s_nop 1
    v_permlane16_swap_b32 v6, v59
    v_add_f32 v6, v6, v59
    v_mov_b32 v59, v6
    s_nop 1
    v_permlane32_swap_b32 v6, v59
    v_add_f32 v6, v6, v59
    s_mul_i32 s64, s31, 2560
    s_add_u32 s64, s64, 2048
    v_lshlrev_b32 v56, 4, v0
    v_lshlrev_b32 v57, 3, v0
    v_add_u32 v52, s64, v56
    v_add_u32 v53, s64, v57
    ds_write_b128 v52, v[32:35]
    ds_write_b128 v52, v[36:39] offset:1024
    ds_write_b32 v53, v6 offset:2048
    ds_write_b32 v53, v5 offset:2052
    s_waitcnt lgkmcnt(0)
    s_mov_b64 exec, 1
    ds_add_rtn_u32 v54, v26, v27 offset:8
    s_mov_b64 exec, -1
    s_sub_u32 s64, 6656, s64
    v_add_u32 v52, s64, v56
    v_add_u32 v53, s64, v57
    s_waitcnt lgkmcnt(0)
    v_readfirstlane_b32 s64, v54
    s_cmp_eq_u32 s64, 0
    s_nop 3
    s_cbranch_scc1 L_nopub
    ds_read_b64 v[54:55], v53 offset:2048
    ds_read_b128 v[40:43], v52
    ds_read_b128 v[44:47], v52 offset:1024
    s_waitcnt lgkmcnt(2)
    v_max_f32 v5, v5, v55
    v_mul_f32 v55, s62, v55
    v_max_f32 v56, v7, v55
    v_sub_f32 v57, v7, v56
    v_sub_f32 v58, v55, v56
    v_exp_f32 v57, v57
    v_exp_f32 v58, v58
    v_mov_b32 v7, v56
    v_mul_f32 v6, v6, v57
    v_fmac_f32 v6, v54, v58
    v_mov_b32_dpp v52, v57 row_newbcast:0 row_mask:0x3 bank_mask:0xf
    v_mov_b32_dpp v52, v57 row_newbcast:8 row_mask:0xc bank_mask:0xf
    v_mov_b32_dpp v53, v58 row_newbcast:0 row_mask:0x3 bank_mask:0xf
    v_mov_b32_dpp v53, v58 row_newbcast:8 row_mask:0xc bank_mask:0xf
    v_mul_f32 v32, v32, v52
    v_mul_f32 v33, v33, v52
    v_mul_f32 v34, v34, v52
    v_mul_f32 v35, v35, v52
    v_mul_f32 v36, v36, v52
    v_mul_f32 v37, v37, v52
    v_mul_f32 v38, v38, v52
    v_mul_f32 v39, v39, v52
    s_waitcnt lgkmcnt(0)
    v_fmac_f32 v32, v40, v53
    v_fmac_f32 v33, v41, v53
    v_fmac_f32 v34, v42, v53
    v_fmac_f32 v35, v43, v53
    v_fmac_f32 v36, v44, v53
    v_fmac_f32 v37, v45, v53
    v_fmac_f32 v38, v46, v53
    v_fmac_f32 v39, v47, v53
    v_lshlrev_b32 v52, 4, v0
    v_lshlrev_b32 v53, 3, v0
    v_mov_b32 v54, v5
    v_mov_b32 v55, v6
    ds_write_b128 v52, v[32:35] offset:7168
    ds_write_b128 v52, v[36:39] offset:8192
    ds_write_b64 v53, v[54:55] offset:9216
    s_waitcnt lgkmcnt(0)
    s_mov_b64 exec, 1
    ds_add_u32 v26, v27 offset:8
    s_mov_b64 exec, -1
L_nopub:
    v_mov_b32 v52, 1540
    s_mov_b32 s65, 1048576
    s_nop 0
L_go:
    ds_read_b32 v53, v52
    s_waitcnt lgkmcnt(0)
    v_readfirstlane_b32 s64, v53
    s_cmp_ge_u32 s64, 1
    s_nop 3
    s_cbranch_scc1 L_god
    s_sleep 2
    s_sub_u32 s65, s65, 1
    s_cmp_lg_u32 s65, 0
    s_cbranch_scc1 L_go
L_god:
    v_lshlrev_b32 v4, 2, v0
    v_add_u32 v4, s63, v4
    v_lshlrev_b32 v52, 4, v2
    ds_read_b128 v[16:19], v52 offset:1024
    ds_read_b128 v[20:23], v52 offset:1280
    v_mov_b32 v5, 0xff800000
    s_waitcnt lgkmcnt(0)
    s_mov_b32 s60, 28
L_ph2:
    s_cmp_eq_u32 s53, 54
    s_cbranch_scc0 L_rka
    s_mov_b64 exec, 1
    v_mov_b32 v63, 1
    buffer_atomic_add v63, off, s[36:39], s91 offset:4 sc0 sc1
    s_mov_b64 exec, -1
L_rka:
    s_cmp_eq_u32 s53, 55
    s_cbranch_scc0 L_rkb
    v_readfirstlane_b32 s90, v63
    s_mov_b32 s58, 4294967239
    s_min_u32 s88, s90, 12
    s_addc_u32 s95, s95, 0
    s_add_u32 s58, s58, s88
    s_min_u32 s88, s90, 23
    s_addc_u32 s95, s95, 0
    s_add_u32 s58, s58, s88
    s_min_u32 s88, s90, 29
    s_addc_u32 s95, s95, 0
    s_add_u32 s58, s58, s88
    s_add_u32 s59, s59, s95
    s_add_u32 s60, s60, s95
L_rkb:
    s_waitcnt vmcnt(9)
    buffer_load_dwordx4 v[104:107], v1, s[32:35], s52 offen offset:2048 nt
    v_dot2_f32_bf16 v48, v64, v16, 0
    v_dot2_f32_bf16 v48, v65, v17, v48
    v_dot2_f32_bf16 v48, v66, v18, v48
    v_dot2_f32_bf16 v48, v67, v19, v48
    s_waitcnt vmcnt(9)
    buffer_load_dwordx4 v[108:111], v1, s[32:35], s52 offen offset:2304 nt
    s_add_u32 s52, s52, 8192
    v_dot2_f32_bf16 v48, v68, v20, v48
    v_dot2_f32_bf16 v48, v69, v21, v48
    v_dot2_f32_bf16 v48, v70, v22, v48
    v_dot2_f32_bf16 v48, v71, v23, v48
    s_waitcnt vmcnt(9)
    buffer_load_dwordx4 v[112:115], v1, s[32:35], s52 offen offset:0 nt
    v_dot2_f32_bf16 v49, v72, v16, 0
    v_dot2_f32_bf16 v49, v73, v17, v49
    v_dot2_f32_bf16 v49, v74, v18, v49
    v_dot2_f32_bf16 v49, v75, v19, v49
    s_waitcnt vmcnt(9)
    buffer_load_dwordx4 v[116:119], v1, s[32:35], s52 offen offset:256 nt
    v_dot2_f32_bf16 v49, v76, v20, v49
    v_dot2_f32_bf16 v49, v77, v21, v49
    v_dot2_f32_bf16 v49, v78, v22, v49
    v_dot2_f32_bf16 v49, v79, v23, v49
    v_add_f32_dpp v52, v48, v48 row_ror:8 row_mask:0xf bank_mask:0xf
    s_nop 1
    v_add_f32_dpp v53, v49, v49 row_ror:8 row_mask:0xf bank_mask:0xf
    v_add_f32_dpp v52, v52, v52 row_half_mirror row_mask:0xf bank_mask:0xf
    s_nop 0
    v_add_f32_dpp v53, v53, v53 row_half_mirror row_mask:0xf bank_mask:0xf
    v_add_f32_dpp v52, v52, v52 quad_perm:[1,0,3,2] row_mask:0xf bank_mask:0xf
    s_nop 0
    v_add_f32_dpp v53, v53, v53 quad_perm:[1,0,3,2] row_mask:0xf bank_mask:0xf
    v_add_f32_dpp v52, v52, v52 quad_perm:[2,3,0,1] row_mask:0xf bank_mask:0xf
    s_nop 0
    v_add_f32_dpp v53, v53, v53 quad_perm:[2,3,0,1] row_mask:0xf bank_mask:0xf
    v_max3_f32 v5, v5, v52, v53
    v_cvt_pk_bf16_f32 v54, v52, v53
    ds_write_b32 v4, v54 offset:0
    s_waitcnt vmcnt(9)
    buffer_load_dwordx4 v[120:123], v1, s[32:35], s52 offen offset:2048 nt
    v_dot2_f32_bf16 v48, v80, v16, 0
    v_dot2_f32_bf16 v48, v81, v17, v48
    v_dot2_f32_bf16 v48, v82, v18, v48
    v_dot2_f32_bf16 v48, v83, v19, v48
    s_waitcnt vmcnt(9)
    buffer_load_dwordx4 v[124:127], v1, s[32:35], s52 offen offset:2304 nt
    s_add_u32 s52, s52, 40960
    s_add_u32 s53, s53, 1
    s_add_u32 s57, s58, s53
    s_lshl_b32 s64, s57, 12
    s_and_b32 s64, s64, 0x1000
    s_lshl_b32 s65, s57, 14
    s_and_b32 s65, s65, 98304
    s_or_b32 s64, s64, s65
    s_lshl_b32 s65, s57, 18
    s_and_b32 s65, s65, 0xe00000
    s_or_b32 s64, s64, s65
    s_add_u32 s64, s64, 1835008
    s_cmp_ge_u32 s53, 57
    s_cselect_b32 s52, s64, s52
    s_cmp_eq_u32 s53, s59
    s_cselect_b32 s32, s84, s32
    s_cselect_b32 s33, s85, s33
    s_cselect_b32 s52, s56, s52
    s_cselect_b32 s53, 29, s53
    v_dot2_f32_bf16 v48, v84, v20, v48
    v_dot2_f32_bf16 v48, v85, v21, v48
    v_dot2_f32_bf16 v48, v86, v22, v48
    v_dot2_f32_bf16 v48, v87, v23, v48
    s_waitcnt vmcnt(9)
    buffer_load_dwordx4 v[64:67], v1, s[32:35], s52 offen offset:0 nt
    v_dot2_f32_bf16 v49, v88, v16, 0
    v_dot2_f32_bf16 v49, v89, v17, v49
    v_dot2_f32_bf16 v49, v90, v18, v49
    v_dot2_f32_bf16 v49, v91, v19, v49
    s_waitcnt vmcnt(9)
    buffer_load_dwordx4 v[68:71], v1, s[32:35], s52 offen offset:256 nt
    v_dot2_f32_bf16 v49, v92, v20, v49
    v_dot2_f32_bf16 v49, v93, v21, v49
    v_dot2_f32_bf16 v49, v94, v22, v49
    v_dot2_f32_bf16 v49, v95, v23, v49
    v_add_f32_dpp v52, v48, v48 row_ror:8 row_mask:0xf bank_mask:0xf
    s_nop 1
    v_add_f32_dpp v53, v49, v49 row_ror:8 row_mask:0xf bank_mask:0xf
    v_add_f32_dpp v52, v52, v52 row_half_mirror row_mask:0xf bank_mask:0xf
    s_nop 0
    v_add_f32_dpp v53, v53, v53 row_half_mirror row_mask:0xf bank_mask:0xf
    v_add_f32_dpp v52, v52, v52 quad_perm:[1,0,3,2] row_mask:0xf bank_mask:0xf
    s_nop 0
    v_add_f32_dpp v53, v53, v53 quad_perm:[1,0,3,2] row_mask:0xf bank_mask:0xf
    v_add_f32_dpp v52, v52, v52 quad_perm:[2,3,0,1] row_mask:0xf bank_mask:0xf
    s_nop 0
    v_add_f32_dpp v53, v53, v53 quad_perm:[2,3,0,1] row_mask:0xf bank_mask:0xf
    v_max3_f32 v5, v5, v52, v53
    v_cvt_pk_bf16_f32 v54, v52, v53
    ds_write_b32 v4, v54 offset:256
    s_waitcnt vmcnt(9)
    buffer_load_dwordx4 v[72:75], v1, s[32:35], s52 offen offset:2048 nt
    v_dot2_f32_bf16 v48, v96, v16, 0
    v_dot2_f32_bf16 v48, v97, v17, v48
    v_dot2_f32_bf16 v48, v98, v18, v48
    v_dot2_f32_bf16 v48, v99, v19, v48
    s_waitcnt vmcnt(9)
    buffer_load_dwordx4 v[76:79], v1, s[32:35], s52 offen offset:2304 nt
    s_add_u32 s52, s52, 8192
    v_dot2_f32_bf16 v48, v100, v20, v48
    v_dot2_f32_bf16 v48, v101, v21, v48
    v_dot2_f32_bf16 v48, v102, v22, v48
    v_dot2_f32_bf16 v48, v103, v23, v48
    s_waitcnt vmcnt(9)
    buffer_load_dwordx4 v[80:83], v1, s[32:35], s52 offen offset:0 nt
    v_dot2_f32_bf16 v49, v104, v16, 0
    v_dot2_f32_bf16 v49, v105, v17, v49
    v_dot2_f32_bf16 v49, v106, v18, v49
    v_dot2_f32_bf16 v49, v107, v19, v49
    s_waitcnt vmcnt(9)
    buffer_load_dwordx4 v[84:87], v1, s[32:35], s52 offen offset:256 nt
    v_dot2_f32_bf16 v49, v108, v20, v49
    v_dot2_f32_bf16 v49, v109, v21, v49
    v_dot2_f32_bf16 v49, v110, v22, v49
    v_dot2_f32_bf16 v49, v111, v23, v49
    v_add_f32_dpp v52, v48, v48 row_ror:8 row_mask:0xf bank_mask:0xf
    s_nop 1
    v_add_f32_dpp v53, v49, v49 row_ror:8 row_mask:0xf bank_mask:0xf
    v_add_f32_dpp v52, v52, v52 row_half_mirror row_mask:0xf bank_mask:0xf
    s_nop 0
    v_add_f32_dpp v53, v53, v53 row_half_mirror row_mask:0xf bank_mask:0xf
    v_add_f32_dpp v52, v52, v52 quad_perm:[1,0,3,2] row_mask:0xf bank_mask:0xf
    s_nop 0
    v_add_f32_dpp v53, v53, v53 quad_perm:[1,0,3,2] row_mask:0xf bank_mask:0xf
    v_add_f32_dpp v52, v52, v52 quad_perm:[2,3,0,1] row_mask:0xf bank_mask:0xf
    s_nop 0
    v_add_f32_dpp v53, v53, v53 quad_perm:[2,3,0,1] row_mask:0xf bank_mask:0xf
    v_max3_f32 v5, v5, v52, v53
    v_cvt_pk_bf16_f32 v54, v52, v53
    ds_write_b32 v4, v54 offset:512
    s_waitcnt vmcnt(9)
    buffer_load_dwordx4 v[88:91], v1, s[32:35], s52 offen offset:2048 nt
    v_dot2_f32_bf16 v48, v112, v16, 0
    v_dot2_f32_bf16 v48, v113, v17, v48
    v_dot2_f32_bf16 v48, v114, v18, v48
    v_dot2_f32_bf16 v48, v115, v19, v48
    s_waitcnt vmcnt(9)
    buffer_load_dwordx4 v[92:95], v1, s[32:35], s52 offen offset:2304 nt
    s_add_u32 s52, s52, 8192
    v_dot2_f32_bf16 v48, v116, v20, v48
    v_dot2_f32_bf16 v48, v117, v21, v48
    v_dot2_f32_bf16 v48, v118, v22, v48
    v_dot2_f32_bf16 v48, v119, v23, v48
    s_waitcnt vmcnt(9)
    buffer_load_dwordx4 v[96:99], v1, s[32:35], s52 offen offset:0 nt
    v_dot2_f32_bf16 v49, v120, v16, 0
    v_dot2_f32_bf16 v49, v121, v17, v49
    v_dot2_f32_bf16 v49, v122, v18, v49
    v_dot2_f32_bf16 v49, v123, v19, v49
    s_waitcnt vmcnt(9)
    buffer_load_dwordx4 v[100:103], v1, s[32:35], s52 offen offset:256 nt
    v_dot2_f32_bf16 v49, v124, v20, v49
    v_dot2_f32_bf16 v49, v125, v21, v49
    v_dot2_f32_bf16 v49, v126, v22, v49
    v_dot2_f32_bf16 v49, v127, v23, v49
    v_add_f32_dpp v52, v48, v48 row_ror:8 row_mask:0xf bank_mask:0xf
    s_nop 1
    v_add_f32_dpp v53, v49, v49 row_ror:8 row_mask:0xf bank_mask:0xf
    v_add_f32_dpp v52, v52, v52 row_half_mirror row_mask:0xf bank_mask:0xf
    s_nop 0
    v_add_f32_dpp v53, v53, v53 row_half_mirror row_mask:0xf bank_mask:0xf
    v_add_f32_dpp v52, v52, v52 quad_perm:[1,0,3,2] row_mask:0xf bank_mask:0xf
    s_nop 0
    v_add_f32_dpp v53, v53, v53 quad_perm:[1,0,3,2] row_mask:0xf bank_mask:0xf
    v_add_f32_dpp v52, v52, v52 quad_perm:[2,3,0,1] row_mask:0xf bank_mask:0xf
    s_nop 0
    v_add_f32_dpp v53, v53, v53 quad_perm:[2,3,0,1] row_mask:0xf bank_mask:0xf
    v_max3_f32 v5, v5, v52, v53
    v_cvt_pk_bf16_f32 v54, v52, v53
    ds_write_b32 v4, v54 offset:768
    v_add_u32 v4, 1024, v4
    s_sub_u32 s60, s60, 1
    s_cmp_lg_u32 s60, 0
    s_cbranch_scc1 L_ph2
    v_lshlrev_b32 v4, 2, v0
    v_add_u32 v4, s63, v4
    ds_read_b32 v60, v4 offset:0
    v_mov_b32 v59, v5
    s_nop 1
    v_permlane16_swap_b32 v5, v59
    v_max_f32 v5, v5, v59
    v_mov_b32 v59, v5
    s_nop 1
    v_permlane32_swap_b32 v5, v59
    v_max_f32 v5, v5, v59
    v_cvt_pk_bf16_f32 v5, v5, v5
    v_and_b32 v5, 0xffff0000, v5
    v_mul_f32 v7, s62, v5
    v_mov_b32 v6, 0
    v_mov_b32 v32, 0
    v_mov_b32 v33, 0
    v_mov_b32 v34, 0
    v_mov_b32 v35, 0
    v_mov_b32 v36, 0
    v_mov_b32 v37, 0
    v_mov_b32 v38, 0
    v_mov_b32 v39, 0
    s_add_u32 s64, s96, 16
    s_and_b32 s65, s2, 15
    s_lshl_b32 s65, s65, 1
    s_add_u32 s65, s65, s31
    s_lshl_b32 s44, s64, 15
    s_lshl_b32 s47, s65, 7
    s_add_u32 s44, s44, s47
    s_add_u32 s44, s44, 524288
    v_and_b32 v25, 1, v3
    v_mul_u32_u24 v25, 12, v25
    v_sub_u32 v25, 20, v25
    s_mov_b32 s46, 0xaaaaaaaa
    s_mov_b32 s47, 0xaaaaaaaa
    v_readfirstlane_b32 s64, v28
    v_readfirstlane_b32 s65, v29
    s_and_b32 s4, s64, 0x7ff
    s_lshr_b32 s5, s64, 11
    s_lshr_b32 s6, s64, 22
    s_lshl_b32 s7, s65, 10
    s_or_b32 s6, s6, s7
    s_lshr_b32 s7, s65, 1
    s_xor_b32 s5, s5, s4
    s_and_b32 s5, s5, 0x7ff
    s_xor_b32 s6, s6, s4
    s_and_b32 s6, s6, 0x7ff
    s_xor_b32 s7, s7, s4
    s_and_b32 s7, s7, 0x7ff
    s_sub_u32 s8, 0x800, s4
    s_sub_u32 s9, 0x800, s5
    s_sub_u32 s10, 0x800, s6
    s_sub_u32 s11, 0x800, s7
    s_add_u32 s60, s95, 26
L_ph3:
    s_waitcnt lgkmcnt(0)
    v_lshlrev_b32 v52, 16, v60
    v_and_b32 v53, 0xffff0000, v60
    ds_read_b32 v61, v4 offset:256
    v_fma_f32 v52, v52, s62, -v7
    v_fma_f32 v53, v53, s62, -v7
    v_exp_f32 v52, v52
    v_exp_f32 v53, v53
    v_add_f32 v6, v6, v52
    v_add_f32 v6, v6, v53
    v_cvt_pk_bf16_f32 v52, v52, v53
    v_perm_b32 v40, v52, v52, v8
    v_perm_b32 v41, v52, v52, v9
    v_perm_b32 v42, v52, v52, v10
    v_perm_b32 v43, v52, v52, v11
    v_perm_b32 v44, v52, v52, v12
    v_perm_b32 v45, v52, v52, v13
    v_perm_b32 v46, v52, v52, v14
    v_perm_b32 v47, v52, v52, v15
    s_waitcnt vmcnt(9)
    buffer_load_dwordx4 v[104:107], v1, s[32:35], s52 offen offset:2048 nt
    v_mfma_f32_16x16x32_bf16 v[32:35], v[40:43], v[64:67], v[32:35]
    s_waitcnt vmcnt(9)
    buffer_load_dwordx4 v[108:111], v1, s[32:35], s52 offen offset:2304 nt
    s_add_u32 s52, s52, 8192
    v_mfma_f32_16x16x32_bf16 v[36:39], v[40:43], v[68:71], v[36:39]
    s_waitcnt vmcnt(9)
    buffer_load_dwordx4 v[112:115], v1, s[32:35], s52 offen offset:0 nt
    v_mfma_f32_16x16x32_bf16 v[32:35], v[44:47], v[72:75], v[32:35]
    s_waitcnt vmcnt(9)
    buffer_load_dwordx4 v[116:119], v1, s[32:35], s52 offen offset:256 nt
    v_mfma_f32_16x16x32_bf16 v[36:39], v[44:47], v[76:79], v[36:39]
    s_waitcnt lgkmcnt(0)
    v_lshlrev_b32 v52, 16, v61
    v_and_b32 v53, 0xffff0000, v61
    ds_read_b32 v60, v4 offset:512
    v_fma_f32 v52, v52, s62, -v7
    v_fma_f32 v53, v53, s62, -v7
    v_exp_f32 v52, v52
    v_exp_f32 v53, v53
    v_add_f32 v6, v6, v52
    v_add_f32 v6, v6, v53
    v_cvt_pk_bf16_f32 v52, v52, v53
    v_perm_b32 v40, v52, v52, v8
    v_perm_b32 v41, v52, v52, v9
    v_perm_b32 v42, v52, v52, v10
    v_perm_b32 v43, v52, v52, v11
    v_perm_b32 v44, v52, v52, v12
    v_perm_b32 v45, v52, v52, v13
    v_perm_b32 v46, v52, v52, v14
    v_perm_b32 v47, v52, v52, v15
    s_waitcnt vmcnt(9)
    buffer_load_dwordx4 v[120:123], v1, s[32:35], s52 offen offset:2048 nt
    v_mfma_f32_16x16x32_bf16 v[32:35], v[40:43], v[80:83], v[32:35]
    s_waitcnt vmcnt(9)
    buffer_load_dwordx4 v[124:127], v1, s[32:35], s52 offen offset:2304 nt
    s_add_u32 s52, s52, 40960
    s_add_u32 s53, s53, 1
    s_add_u32 s57, s58, s53
    s_lshl_b32 s64, s57, 12
    s_and_b32 s64, s64, 0x1000
    s_lshl_b32 s65, s57, 14
    s_and_b32 s65, s65, 98304
    s_or_b32 s64, s64, s65
    s_lshl_b32 s65, s57, 18
    s_and_b32 s65, s65, 0xe00000
    s_or_b32 s64, s64, s65
    s_add_u32 s64, s64, 1835008
    s_cmp_ge_u32 s53, 57
    s_cselect_b32 s52, s64, s52
    v_mfma_f32_16x16x32_bf16 v[36:39], v[40:43], v[84:87], v[36:39]
    s_waitcnt vmcnt(9)
    buffer_load_dwordx4 v[64:67], v1, s[32:35], s52 offen offset:0 nt
    v_mfma_f32_16x16x32_bf16 v[32:35], v[44:47], v[88:91], v[32:35]
    s_waitcnt vmcnt(9)
    buffer_load_dwordx4 v[68:71], v1, s[32:35], s52 offen offset:256 nt
    v_mfma_f32_16x16x32_bf16 v[36:39], v[44:47], v[92:95], v[36:39]
    s_waitcnt lgkmcnt(0)
    v_lshlrev_b32 v52, 16, v60
    v_and_b32 v53, 0xffff0000, v60
    ds_read_b32 v61, v4 offset:768
    v_fma_f32 v52, v52, s62, -v7
    v_fma_f32 v53, v53, s62, -v7
    v_exp_f32 v52, v52
    v_exp_f32 v53, v53
    v_add_f32 v6, v6, v52
    v_add_f32 v6, v6, v53
    v_cvt_pk_bf16_f32 v52, v52, v53
    v_perm_b32 v40, v52, v52, v8
    v_perm_b32 v41, v52, v52, v9
    v_perm_b32 v42, v52, v52, v10
    v_perm_b32 v43, v52, v52, v11
    v_perm_b32 v44, v52, v52, v12
    v_perm_b32 v45, v52, v52, v13
    v_perm_b32 v46, v52, v52, v14
    v_perm_b32 v47, v52, v52, v15
    s_waitcnt vmcnt(9)
    buffer_load_dwordx4 v[72:75], v1, s[32:35], s52 offen offset:2048 nt
    v_mfma_f32_16x16x32_bf16 v[32:35], v[40:43], v[96:99], v[32:35]
    s_waitcnt vmcnt(9)
    buffer_load_dwordx4 v[76:79], v1, s[32:35], s52 offen offset:2304 nt
    s_add_u32 s52, s52, 8192
    v_mfma_f32_16x16x32_bf16 v[36:39], v[40:43], v[100:103], v[36:39]
    s_waitcnt vmcnt(9)
    buffer_load_dwordx4 v[80:83], v1, s[32:35], s52 offen offset:0 nt
    v_mfma_f32_16x16x32_bf16 v[32:35], v[44:47], v[104:107], v[32:35]
    s_waitcnt vmcnt(9)
    buffer_load_dwordx4 v[84:87], v1, s[32:35], s52 offen offset:256 nt
    v_mfma_f32_16x16x32_bf16 v[36:39], v[44:47], v[108:111], v[36:39]
    s_waitcnt lgkmcnt(0)
    v_lshlrev_b32 v52, 16, v61
    v_and_b32 v53, 0xffff0000, v61
    ds_read_b32 v60, v4 offset:1024
    v_fma_f32 v52, v52, s62, -v7
    v_fma_f32 v53, v53, s62, -v7
    v_exp_f32 v52, v52
    v_exp_f32 v53, v53
    v_add_f32 v6, v6, v52
    v_add_f32 v6, v6, v53
    v_cvt_pk_bf16_f32 v52, v52, v53
    v_perm_b32 v40, v52, v52, v8
    v_perm_b32 v41, v52, v52, v9
    v_perm_b32 v42, v52, v52, v10
    v_perm_b32 v43, v52, v52, v11
    v_perm_b32 v44, v52, v52, v12
    v_perm_b32 v45, v52, v52, v13
    v_perm_b32 v46, v52, v52, v14
    v_perm_b32 v47, v52, v52, v15
    s_waitcnt vmcnt(9)
    buffer_load_dwordx4 v[88:91], v1, s[32:35], s52 offen offset:2048 nt
    v_mfma_f32_16x16x32_bf16 v[32:35], v[40:43], v[112:115], v[32:35]
    s_waitcnt vmcnt(9)
    buffer_load_dwordx4 v[92:95], v1, s[32:35], s52 offen offset:2304 nt
    s_add_u32 s52, s52, 8192
    v_mfma_f32_16x16x32_bf16 v[36:39], v[40:43], v[116:119], v[36:39]
    s_waitcnt vmcnt(9)
    buffer_load_dwordx4 v[96:99], v1, s[32:35], s52 offen offset:0 nt
    v_mfma_f32_16x16x32_bf16 v[32:35], v[44:47], v[120:123], v[32:35]
    s_waitcnt vmcnt(9)
    buffer_load_dwordx4 v[100:103], v1, s[32:35], s52 offen offset:256 nt
    v_mfma_f32_16x16x32_bf16 v[36:39], v[44:47], v[124:127], v[36:39]
    v_add_u32 v4, 1024, v4
    s_sub_u32 s60, s60, 1
    s_cmp_lg_u32 s60, 0
    s_nop 4
    s_cbranch_scc1 L_ph3
    buffer_load_dwordx4 v[104:107], v1, s[32:35], s52 offen offset:2048 nt
    buffer_load_dwordx4 v[108:111], v1, s[32:35], s52 offen offset:2304 nt
    s_add_u32 s52, s52, 8192
    s_waitcnt lgkmcnt(0)
    v_lshlrev_b32 v52, 16, v60
    v_and_b32 v53, 0xffff0000, v60
    ds_read_b32 v61, v4 offset:256
    v_fma_f32 v52, v52, s62, -v7
    v_fma_f32 v53, v53, s62, -v7
    v_exp_f32 v52, v52
    v_exp_f32 v53, v53
    v_add_f32 v6, v6, v52
    v_add_f32 v6, v6, v53
    v_cvt_pk_bf16_f32 v52, v52, v53
    v_perm_b32 v40, v52, v52, v8
    v_perm_b32 v41, v52, v52, v9
    v_perm_b32 v42, v52, v52, v10
    v_perm_b32 v43, v52, v52, v11
    v_perm_b32 v44, v52, v52, v12
    v_perm_b32 v45, v52, v52, v13
    v_perm_b32 v46, v52, v52, v14
    v_perm_b32 v47, v52, v52, v15
    s_waitcnt vmcnt(11)
    buffer_load_dwordx4 v[112:115], v1, s[32:35], s52 offen offset:0 nt
    v_mfma_f32_16x16x32_bf16 v[32:35], v[40:43], v[64:67], v[32:35]
    s_waitcnt vmcnt(11)
    buffer_load_dwordx4 v[116:119], v1, s[32:35], s52 offen offset:256 nt
    v_mfma_f32_16x16x32_bf16 v[36:39], v[40:43], v[68:71], v[36:39]
    s_waitcnt vmcnt(11)
    buffer_load_dwordx4 v[120:123], v1, s[32:35], s52 offen offset:2048 nt
    v_mfma_f32_16x16x32_bf16 v[32:35], v[44:47], v[72:75], v[32:35]
    s_waitcnt vmcnt(11)
    buffer_load_dwordx4 v[124:127], v1, s[32:35], s52 offen offset:2304 nt
    s_add_u32 s52, s52, 40960
    s_add_u32 s53, s53, 1
    s_add_u32 s57, s58, s53
    s_lshl_b32 s64, s57, 12
    s_and_b32 s64, s64, 0x1000
    s_lshl_b32 s65, s57, 14
    s_and_b32 s65, s65, 98304
    s_or_b32 s64, s64, s65
    s_lshl_b32 s65, s57, 18
    s_and_b32 s65, s65, 0xe00000
    s_or_b32 s64, s64, s65
    s_add_u32 s64, s64, 1835008
    s_cmp_ge_u32 s53, 57
    s_cselect_b32 s52, s64, s52
    v_mfma_f32_16x16x32_bf16 v[36:39], v[44:47], v[76:79], v[36:39]
    s_waitcnt lgkmcnt(0)
    v_lshlrev_b32 v52, 16, v61
    v_and_b32 v53, 0xffff0000, v61
    ds_read_b32 v60, v4 offset:512
    v_fma_f32 v52, v52, s62, -v7
    v_fma_f32 v53, v53, s62, -v7
    v_exp_f32 v52, v52
    v_exp_f32 v53, v53
    v_add_f32 v6, v6, v52
    v_add_f32 v6, v6, v53
    v_cvt_pk_bf16_f32 v52, v52, v53
    v_perm_b32 v40, v52, v52, v8
    v_perm_b32 v41, v52, v52, v9
    v_perm_b32 v42, v52, v52, v10
    v_perm_b32 v43, v52, v52, v11
    v_perm_b32 v44, v52, v52, v12
    v_perm_b32 v45, v52, v52, v13
    v_perm_b32 v46, v52, v52, v14
    v_perm_b32 v47, v52, v52, v15
    s_waitcnt vmcnt(11)
    buffer_load_dwordx4 v[64:67], v1, s[32:35], s52 offen offset:0 nt
    v_mfma_f32_16x16x32_bf16 v[32:35], v[40:43], v[80:83], v[32:35]
    s_waitcnt vmcnt(11)
    buffer_load_dwordx4 v[68:71], v1, s[32:35], s52 offen offset:256 nt
    v_mfma_f32_16x16x32_bf16 v[36:39], v[40:43], v[84:87], v[36:39]
    s_waitcnt vmcnt(11)
    buffer_load_dwordx4 v[72:75], v1, s[32:35], s52 offen offset:2048 nt
    v_mfma_f32_16x16x32_bf16 v[32:35], v[44:47], v[88:91], v[32:35]
    s_waitcnt vmcnt(11)
    s_mov_b64 exec, 1
    v_mov_b32 v63, 1
    buffer_atomic_add v63, off, s[36:39], s91 sc0 sc1
    s_mov_b64 exec, -1
    buffer_load_dwordx4 v[76:79], v1, s[32:35], s52 offen offset:2304 nt
    s_add_u32 s52, s52, 8192
    v_mfma_f32_16x16x32_bf16 v[36:39], v[44:47], v[92:95], v[36:39]
    s_waitcnt lgkmcnt(0)
    v_lshlrev_b32 v52, 16, v60
    v_and_b32 v53, 0xffff0000, v60
    ds_read_b32 v61, v4 offset:768
    v_fma_f32 v52, v52, s62, -v7
    v_fma_f32 v53, v53, s62, -v7
    v_exp_f32 v52, v52
    v_exp_f32 v53, v53
    v_add_f32 v6, v6, v52
    v_add_f32 v6, v6, v53
    v_cvt_pk_bf16_f32 v52, v52, v53
    v_perm_b32 v40, v52, v52, v8
    v_perm_b32 v41, v52, v52, v9
    v_perm_b32 v42, v52, v52, v10
    v_perm_b32 v43, v52, v52, v11
    v_perm_b32 v44, v52, v52, v12
    v_perm_b32 v45, v52, v52, v13
    v_perm_b32 v46, v52, v52, v14
    v_perm_b32 v47, v52, v52, v15
    s_waitcnt vmcnt(12)
    buffer_load_dwordx4 v[80:83], v1, s[32:35], s52 offen offset:0 nt
    v_mfma_f32_16x16x32_bf16 v[32:35], v[40:43], v[96:99], v[32:35]
    s_waitcnt vmcnt(12)
    buffer_load_dwordx4 v[84:87], v1, s[32:35], s52 offen offset:256 nt
    v_mfma_f32_16x16x32_bf16 v[36:39], v[40:43], v[100:103], v[36:39]
    s_waitcnt vmcnt(12)
    buffer_load_dwordx4 v[88:91], v1, s[32:35], s52 offen offset:2048 nt
    v_mfma_f32_16x16x32_bf16 v[32:35], v[44:47], v[104:107], v[32:35]
    s_waitcnt vmcnt(12)
    buffer_load_dwordx4 v[92:95], v1, s[32:35], s52 offen offset:2304 nt
    s_add_u32 s52, s52, 8192
    v_mfma_f32_16x16x32_bf16 v[36:39], v[44:47], v[108:111], v[36:39]
    s_waitcnt lgkmcnt(0)
    v_lshlrev_b32 v52, 16, v61
    v_and_b32 v53, 0xffff0000, v61
    ds_read_b32 v60, v4 offset:1024
    v_fma_f32 v52, v52, s62, -v7
    v_fma_f32 v53, v53, s62, -v7
    v_exp_f32 v52, v52
    v_exp_f32 v53, v53
    v_add_f32 v6, v6, v52
    v_add_f32 v6, v6, v53
    v_cvt_pk_bf16_f32 v52, v52, v53
    v_perm_b32 v40, v52, v52, v8
    v_perm_b32 v41, v52, v52, v9
    v_perm_b32 v42, v52, v52, v10
    v_perm_b32 v43, v52, v52, v11
    v_perm_b32 v44, v52, v52, v12
    v_perm_b32 v45, v52, v52, v13
    v_perm_b32 v46, v52, v52, v14
    v_perm_b32 v47, v52, v52, v15
    s_waitcnt vmcnt(12)
    buffer_load_dwordx4 v[96:99], v1, s[32:35], s52 offen offset:0 nt
    v_mfma_f32_16x16x32_bf16 v[32:35], v[40:43], v[112:115], v[32:35]
    s_waitcnt vmcnt(12)
    buffer_load_dwordx4 v[100:103], v1, s[32:35], s52 offen offset:256 nt
    v_mfma_f32_16x16x32_bf16 v[36:39], v[40:43], v[116:119], v[36:39]
    s_waitcnt vmcnt(12)
    buffer_load_dwordx4 v[104:107], v1, s[32:35], s52 offen offset:2048 nt
    v_mfma_f32_16x16x32_bf16 v[32:35], v[44:47], v[120:123], v[32:35]
    s_waitcnt vmcnt(12)
    buffer_load_dwordx4 v[108:111], v1, s[32:35], s52 offen offset:2304 nt
    s_add_u32 s52, s52, 8192
    v_mfma_f32_16x16x32_bf16 v[36:39], v[44:47], v[124:127], v[36:39]
    s_waitcnt lgkmcnt(0)
    v_lshlrev_b32 v52, 16, v60
    v_and_b32 v53, 0xffff0000, v60
    ds_read_b32 v61, v4 offset:1280
    v_fma_f32 v52, v52, s62, -v7
    v_fma_f32 v53, v53, s62, -v7
    v_exp_f32 v52, v52
    v_exp_f32 v53, v53
    v_add_f32 v6, v6, v52
    v_add_f32 v6, v6, v53
    v_cvt_pk_bf16_f32 v52, v52, v53
    v_perm_b32 v40, v52, v52, v8
    v_perm_b32 v41, v52, v52, v9
    v_perm_b32 v42, v52, v52, v10
    v_perm_b32 v43, v52, v52, v11
    v_perm_b32 v44, v52, v52, v12
    v_perm_b32 v45, v52, v52, v13
    v_perm_b32 v46, v52, v52, v14
    v_perm_b32 v47, v52, v52, v15
    s_waitcnt vmcnt(12)
    buffer_load_dwordx4 v[112:115], v1, s[32:35], s52 offen offset:0 nt
    v_mfma_f32_16x16x32_bf16 v[32:35], v[40:43], v[64:67], v[32:35]
    s_waitcnt vmcnt(12)
    buffer_load_dwordx4 v[116:119], v1, s[32:35], s52 offen offset:256 nt
    v_mfma_f32_16x16x32_bf16 v[36:39], v[40:43], v[68:71], v[36:39]
    s_waitcnt vmcnt(12)
    buffer_load_dwordx4 v[120:123], v1, s[32:35], s52 offen offset:2048 nt
    v_mfma_f32_16x16x32_bf16 v[32:35], v[44:47], v[72:75], v[32:35]
    s_waitcnt vmcnt(11)
    buffer_load_dwordx4 v[124:127], v1, s[32:35], s52 offen offset:2304 nt
    s_add_u32 s52, s52, 40960
    s_add_u32 s53, s53, 1
    s_add_u32 s57, s58, s53
    s_lshl_b32 s64, s57, 12
    s_and_b32 s64, s64, 0x1000
    s_lshl_b32 s65, s57, 14
    s_and_b32 s65, s65, 98304
    s_or_b32 s64, s64, s65
    s_lshl_b32 s65, s57, 18
    s_and_b32 s65, s65, 0xe00000
    s_or_b32 s64, s64, s65
    s_add_u32 s64, s64, 1835008
    s_cmp_ge_u32 s53, 57
    s_cselect_b32 s52, s64, s52
    v_mfma_f32_16x16x32_bf16 v[36:39], v[44:47], v[76:79], v[36:39]
    s_waitcnt lgkmcnt(0)
    v_lshlrev_b32 v52, 16, v61
    v_and_b32 v53, 0xffff0000, v61
    ds_read_b32 v60, v4 offset:1536
    v_fma_f32 v52, v52, s62, -v7
    v_fma_f32 v53, v53, s62, -v7
    v_exp_f32 v52, v52
    v_exp_f32 v53, v53
    v_add_f32 v6, v6, v52
    v_add_f32 v6, v6, v53
    v_cvt_pk_bf16_f32 v52, v52, v53
    v_perm_b32 v40, v52, v52, v8
    v_perm_b32 v41, v52, v52, v9
    v_perm_b32 v42, v52, v52, v10
    v_perm_b32 v43, v52, v52, v11
    v_perm_b32 v44, v52, v52, v12
    v_perm_b32 v45, v52, v52, v13
    v_perm_b32 v46, v52, v52, v14
    v_perm_b32 v47, v52, v52, v15
    s_waitcnt vmcnt(11)
    v_readfirstlane_b32 s90, v63
    s_bfe_u32 s88, s90, 196612
    s_lshl_b32 s88, s88, 21
    s_lshr_b32 s89, s90, 7
    s_lshl_b32 s89, s89, 17
    s_add_u32 s88, s88, s89
    s_add_u32 s89, s90, s96
    s_and_b32 s89, s89, 15
    s_lshl_b32 s89, s89, 13
    s_add_u32 s88, s88, s89
    s_add_u32 s88, s88, 1966080
    s_cmp_ge_u32 s90, 112
    s_cselect_b32 s89, 1, 0
    v_mov_b32 v30, s89
    s_mov_b64 exec, 1
    ds_max_u32 v26, v30 offset:12
    s_mov_b64 exec, -1
    s_cmp_lt_u32 s90, 128
    s_cselect_b32 s88, s88, 0
    s_cselect_b32 s82, s82, 0
    s_cselect_b32 s86, s86, 0
    buffer_load_dwordx4 v[64:67], v1, s[80:83], s88 offen offset:0 nt
    v_mfma_f32_16x16x32_bf16 v[32:35], v[40:43], v[80:83], v[32:35]
    s_waitcnt vmcnt(11)
    buffer_load_dwordx4 v[68:71], v1, s[80:83], s88 offen offset:256 nt
    v_mfma_f32_16x16x32_bf16 v[36:39], v[40:43], v[84:87], v[36:39]
    s_waitcnt vmcnt(11)
    buffer_load_dwordx4 v[72:75], v1, s[80:83], s88 offen offset:2048 nt
    v_mfma_f32_16x16x32_bf16 v[32:35], v[44:47], v[88:91], v[32:35]
    s_waitcnt vmcnt(11)
    s_mov_b64 exec, 1
    v_mov_b32 v63, 1
    buffer_atomic_add v63, off, s[36:39], s91 sc0 sc1
    s_mov_b64 exec, -1
    buffer_load_dwordx4 v[76:79], v1, s[80:83], s88 offen offset:2304 nt
    v_mfma_f32_16x16x32_bf16 v[36:39], v[44:47], v[92:95], v[36:39]
    s_waitcnt lgkmcnt(0)
    v_lshlrev_b32 v52, 16, v60
    v_and_b32 v53, 0xffff0000, v60
    ds_read_b32 v61, v4 offset:1792
    v_fma_f32 v52, v52, s62, -v7
    v_fma_f32 v53, v53, s62, -v7
    v_exp_f32 v52, v52
    v_exp_f32 v53, v53
    v_add_f32 v6, v6, v52
    v_add_f32 v6, v6, v53
    v_cvt_pk_bf16_f32 v52, v52, v53
    v_perm_b32 v40, v52, v52, v8
    v_perm_b32 v41, v52, v52, v9
    v_perm_b32 v42, v52, v52, v10
    v_perm_b32 v43, v52, v52, v11
    v_perm_b32 v44, v52, v52, v12
    v_perm_b32 v45, v52, v52, v13
    v_perm_b32 v46, v52, v52, v14
    v_perm_b32 v47, v52, v52, v15
    s_waitcnt vmcnt(12)
    buffer_load_dwordx4 v[80:83], v62, s[80:83], s88 offen offset:0 nt
    v_mfma_f32_16x16x32_bf16 v[32:35], v[40:43], v[96:99], v[32:35]
    s_waitcnt vmcnt(12)
    buffer_load_dwordx4 v[84:87], v62, s[80:83], s88 offen offset:256 nt
    v_mfma_f32_16x16x32_bf16 v[36:39], v[40:43], v[100:103], v[36:39]
    s_waitcnt vmcnt(12)
    buffer_load_dwordx4 v[88:91], v62, s[80:83], s88 offen offset:2048 nt
    v_mfma_f32_16x16x32_bf16 v[32:35], v[44:47], v[104:107], v[32:35]
    s_waitcnt vmcnt(12)
    buffer_load_dwordx4 v[92:95], v62, s[80:83], s88 offen offset:2304 nt
    v_mfma_f32_16x16x32_bf16 v[36:39], v[44:47], v[108:111], v[36:39]
    s_waitcnt lgkmcnt(0)
    v_lshlrev_b32 v52, 16, v61
    v_and_b32 v53, 0xffff0000, v61
    ds_read_b32 v60, v4 offset:2048
    v_fma_f32 v52, v52, s62, -v7
    v_fma_f32 v53, v53, s62, -v7
    v_exp_f32 v52, v52
    v_exp_f32 v53, v53
    v_add_f32 v6, v6, v52
    v_add_f32 v6, v6, v53
    v_cvt_pk_bf16_f32 v52, v52, v53
    v_perm_b32 v40, v52, v52, v8
    v_perm_b32 v41, v52, v52, v9
    v_perm_b32 v42, v52, v52, v10
    v_perm_b32 v43, v52, v52, v11
    v_perm_b32 v44, v52, v52, v12
    v_perm_b32 v45, v52, v52, v13
    v_perm_b32 v46, v52, v52, v14
    v_perm_b32 v47, v52, v52, v15
    s_waitcnt vmcnt(12)
    buffer_load_dwordx4 v[96:99], v1, s[84:87], s88 offen offset:0 nt
    v_mfma_f32_16x16x32_bf16 v[32:35], v[40:43], v[112:115], v[32:35]
    s_waitcnt vmcnt(12)
    buffer_load_dwordx4 v[100:103], v1, s[84:87], s88 offen offset:256 nt
    v_mfma_f32_16x16x32_bf16 v[36:39], v[40:43], v[116:119], v[36:39]
    s_waitcnt vmcnt(12)
    buffer_load_dwordx4 v[104:107], v1, s[84:87], s88 offen offset:2048 nt
    v_mfma_f32_16x16x32_bf16 v[32:35], v[44:47], v[120:123], v[32:35]
    s_waitcnt vmcnt(12)
    buffer_load_dwordx4 v[108:111], v1, s[84:87], s88 offen offset:2304 nt
    v_mfma_f32_16x16x32_bf16 v[36:39], v[44:47], v[124:127], v[36:39]
    s_cmp_eq_u32 s88, 0
    s_nop 6
    s_cbranch_scc1 L_pool_end
L_pool:
    s_waitcnt vmcnt(12)
    buffer_load_dwordx4 v[112:115], v62, s[84:87], s88 offen offset:0 nt
    v_dot2_f32_bf16 v48, v64, v16, 0
    v_dot2_f32_bf16 v48, v65, v17, v48
    v_dot2_f32_bf16 v48, v66, v18, v48
    v_dot2_f32_bf16 v48, v67, v19, v48
    s_waitcnt vmcnt(12)
    buffer_load_dwordx4 v[116:119], v62, s[84:87], s88 offen offset:256 nt
    v_dot2_f32_bf16 v48, v68, v20, v48
    v_dot2_f32_bf16 v48, v69, v21, v48
    v_dot2_f32_bf16 v48, v70, v22, v48
    v_dot2_f32_bf16 v48, v71, v23, v48
    s_waitcnt vmcnt(12)
    buffer_load_dwordx4 v[120:123], v62, s[84:87], s88 offen offset:2048 nt
    v_dot2_f32_bf16 v49, v72, v16, 0
    v_dot2_f32_bf16 v49, v73, v17, v49
    v_dot2_f32_bf16 v49, v74, v18, v49
    v_dot2_f32_bf16 v49, v75, v19, v49
    s_waitcnt vmcnt(11)
    buffer_load_dwordx4 v[124:127], v62, s[84:87], s88 offen offset:2304 nt
    v_dot2_f32_bf16 v49, v76, v20, v49
    v_dot2_f32_bf16 v49, v77, v21, v49
    v_dot2_f32_bf16 v49, v78, v22, v49
    v_dot2_f32_bf16 v49, v79, v23, v49
    s_waitcnt vmcnt(11)
    v_readfirstlane_b32 s90, v63
    s_bfe_u32 s88, s90, 196612
    s_lshl_b32 s88, s88, 21
    s_lshr_b32 s89, s90, 7
    s_lshl_b32 s89, s89, 17
    s_add_u32 s88, s88, s89
    s_add_u32 s89, s90, s96
    s_and_b32 s89, s89, 15
    s_lshl_b32 s89, s89, 13
    s_add_u32 s88, s88, s89
    s_add_u32 s88, s88, 1966080
    s_cmp_ge_u32 s90, 112
    s_cselect_b32 s89, 1, 0
    v_mov_b32 v30, s89
    s_mov_b64 exec, 1
    ds_max_u32 v26, v30 offset:12
    s_mov_b64 exec, -1
    s_cmp_lt_u32 s90, 128
    s_cselect_b32 s88, s88, 0
    s_cselect_b32 s82, s82, 0
    s_cselect_b32 s86, s86, 0
    buffer_load_dwordx4 v[64:67], v1, s[80:83], s88 offen offset:0 nt
    v_dot2_f32_bf16 v50, v80, v16, 0
    v_dot2_f32_bf16 v50, v81, v17, v50
    v_dot2_f32_bf16 v50, v82, v18, v50
    v_dot2_f32_bf16 v50, v83, v19, v50
    s_waitcnt vmcnt(11)
    buffer_load_dwordx4 v[68:71], v1, s[80:83], s88 offen offset:256 nt
    v_dot2_f32_bf16 v50, v84, v20, v50
    v_dot2_f32_bf16 v50, v85, v21, v50
    v_dot2_f32_bf16 v50, v86, v22, v50
    v_dot2_f32_bf16 v50, v87, v23, v50
    s_waitcnt vmcnt(11)
    buffer_load_dwordx4 v[72:75], v1, s[80:83], s88 offen offset:2048 nt
    v_dot2_f32_bf16 v51, v88, v16, 0
    v_dot2_f32_bf16 v51, v89, v17, v51
    v_dot2_f32_bf16 v51, v90, v18, v51
    v_dot2_f32_bf16 v51, v91, v19, v51
    s_waitcnt vmcnt(11)
    s_mov_b64 exec, 1
    v_mov_b32 v63, 1
    buffer_atomic_add v63, off, s[36:39], s91 sc0 sc1
    s_mov_b64 exec, -1
    buffer_load_dwordx4 v[76:79], v1, s[80:83], s88 offen offset:2304 nt
    v_dot2_f32_bf16 v51, v92, v20, v51
    v_dot2_f32_bf16 v51, v93, v21, v51
    v_dot2_f32_bf16 v51, v94, v22, v51
    v_dot2_f32_bf16 v51, v95, v23, v51
    v_add_f32_dpp v52, v48, v48 row_ror:8 row_mask:0xf bank_mask:0xf
    v_add_f32_dpp v53, v49, v49 row_ror:8 row_mask:0xf bank_mask:0xf
    v_add_f32_dpp v54, v50, v50 row_ror:8 row_mask:0xf bank_mask:0xf
    v_add_f32_dpp v55, v51, v51 row_ror:8 row_mask:0xf bank_mask:0xf
    v_add_f32_dpp v52, v52, v52 row_half_mirror row_mask:0xf bank_mask:0xf
    v_add_f32_dpp v53, v53, v53 row_half_mirror row_mask:0xf bank_mask:0xf
    v_add_f32_dpp v54, v54, v54 row_half_mirror row_mask:0xf bank_mask:0xf
    v_add_f32_dpp v55, v55, v55 row_half_mirror row_mask:0xf bank_mask:0xf
    v_add_f32_dpp v52, v52, v52 quad_perm:[1,0,3,2] row_mask:0xf bank_mask:0xf
    v_add_f32_dpp v53, v53, v53 quad_perm:[1,0,3,2] row_mask:0xf bank_mask:0xf
    v_add_f32_dpp v54, v54, v54 quad_perm:[1,0,3,2] row_mask:0xf bank_mask:0xf
    v_add_f32_dpp v55, v55, v55 quad_perm:[1,0,3,2] row_mask:0xf bank_mask:0xf
    v_add_f32_dpp v52, v52, v52 quad_perm:[2,3,0,1] row_mask:0xf bank_mask:0xf
    v_add_f32_dpp v53, v53, v53 quad_perm:[2,3,0,1] row_mask:0xf bank_mask:0xf
    v_add_f32_dpp v54, v54, v54 quad_perm:[2,3,0,1] row_mask:0xf bank_mask:0xf
    v_add_f32_dpp v55, v55, v55 quad_perm:[2,3,0,1] row_mask:0xf bank_mask:0xf
    v_cvt_pk_bf16_f32 v56, v52, v53
    v_cvt_pk_bf16_f32 v57, v54, v55
    v_lshlrev_b32 v52, 16, v56
    v_and_b32 v53, 0xffff0000, v56
    v_lshlrev_b32 v54, 16, v57
    v_and_b32 v55, 0xffff0000, v57
    v_max3_f32 v56, v52, v53, v54
    v_max_f32 v56, v56, v55
    v_cmp_gt_f32 vcc, v56, v5
    s_cmp_eq_u64 vcc, 0
    s_nop 3
    s_cbranch_scc1 L_norescale
    v_max_f32 v5, v5, v56
    v_mov_b32 v59, v5
    s_nop 1
    v_permlane16_swap_b32 v5, v59
    v_max_f32 v5, v5, v59
    v_mov_b32 v59, v5
    s_nop 1
    v_permlane32_swap_b32 v5, v59
    v_max_f32 v5, v5, v59
    v_mul_f32 v56, s62, v5
    v_sub_f32 v57, v7, v56
    v_exp_f32 v57, v57
    v_mov_b32 v7, v56
    v_mul_f32 v6, v6, v57
    v_mul_f32 v32, v32, v57
    v_mul_f32 v33, v33, v57
    v_mul_f32 v34, v34, v57
    v_mul_f32 v35, v35, v57
    v_mul_f32 v36, v36, v57
    v_mul_f32 v37, v37, v57
    v_mul_f32 v38, v38, v57
    v_mul_f32 v39, v39, v57
    s_nop 1
L_norescale:
    v_fma_f32 v52, v52, s62, -v7
    v_fma_f32 v53, v53, s62, -v7
    v_exp_f32 v52, v52
    v_exp_f32 v53, v53
    v_add_f32 v6, v6, v52
    v_add_f32 v6, v6, v53
    v_cvt_pk_bf16_f32 v52, v52, v53
    v_perm_b32 v40, v52, v52, v8
    v_perm_b32 v41, v52, v52, v9
    v_perm_b32 v42, v52, v52, v10
    v_perm_b32 v43, v52, v52, v11
    v_perm_b32 v44, v52, v52, v12
    v_perm_b32 v45, v52, v52, v13
    v_perm_b32 v46, v52, v52, v14
    v_perm_b32 v47, v52, v52, v15
    s_waitcnt vmcnt(12)
    buffer_load_dwordx4 v[80:83], v62, s[80:83], s88 offen offset:0 nt
    v_mfma_f32_16x16x32_bf16 v[32:35], v[40:43], v[96:99], v[32:35]
    s_waitcnt vmcnt(12)
    buffer_load_dwordx4 v[84:87], v62, s[80:83], s88 offen offset:256 nt
    v_mfma_f32_16x16x32_bf16 v[36:39], v[40:43], v[100:103], v[36:39]
    s_waitcnt vmcnt(12)
    buffer_load_dwordx4 v[88:91], v62, s[80:83], s88 offen offset:2048 nt
    v_mfma_f32_16x16x32_bf16 v[32:35], v[44:47], v[104:107], v[32:35]
    s_waitcnt vmcnt(12)
    buffer_load_dwordx4 v[92:95], v62, s[80:83], s88 offen offset:2304 nt
    v_mfma_f32_16x16x32_bf16 v[36:39], v[44:47], v[108:111], v[36:39]
    v_fma_f32 v54, v54, s62, -v7
    v_fma_f32 v55, v55, s62, -v7
    v_exp_f32 v54, v54
    v_exp_f32 v55, v55
    v_add_f32 v6, v6, v54
    v_add_f32 v6, v6, v55
    v_cvt_pk_bf16_f32 v54, v54, v55
    v_perm_b32 v40, v54, v54, v8
    v_perm_b32 v41, v54, v54, v9
    v_perm_b32 v42, v54, v54, v10
    v_perm_b32 v43, v54, v54, v11
    v_perm_b32 v44, v54, v54, v12
    v_perm_b32 v45, v54, v54, v13
    v_perm_b32 v46, v54, v54, v14
    v_perm_b32 v47, v54, v54, v15
    s_waitcnt vmcnt(12)
    buffer_load_dwordx4 v[96:99], v1, s[84:87], s88 offen offset:0 nt
    v_mfma_f32_16x16x32_bf16 v[32:35], v[40:43], v[112:115], v[32:35]
    s_waitcnt vmcnt(12)
    buffer_load_dwordx4 v[100:103], v1, s[84:87], s88 offen offset:256 nt
    v_mfma_f32_16x16x32_bf16 v[36:39], v[40:43], v[116:119], v[36:39]
    s_waitcnt vmcnt(12)
    buffer_load_dwordx4 v[104:107], v1, s[84:87], s88 offen offset:2048 nt
    v_mfma_f32_16x16x32_bf16 v[32:35], v[44:47], v[120:123], v[32:35]
    s_waitcnt vmcnt(12)
    buffer_load_dwordx4 v[108:111], v1, s[84:87], s88 offen offset:2304 nt
    v_mfma_f32_16x16x32_bf16 v[36:39], v[44:47], v[124:127], v[36:39]
    s_cmp_lg_u32 s88, 0
    s_nop 6
    s_cbranch_scc1 L_pool
L_pool_end:
    v_mov_b32 v59, v6
    s_nop 1
    v_permlane16_swap_b32 v6, v59
    v_add_f32 v6, v6, v59
    v_mov_b32 v59, v6
    s_nop 1
    v_permlane32_swap_b32 v6, v59
    v_add_f32 v6, v6, v59
    v_add_u32 v6, 0x80, v6
    v_cndmask_b32 v52, v5, v6, s[46:47]
    v_bfe_u32 v52, v52, v25, 12
    v_permlane32_swap_b32 v32, v36
    v_permlane32_swap_b32 v33, v37
    v_permlane32_swap_b32 v34, v38
    v_permlane32_swap_b32 v35, v39
    v_add_u32 v32, s8, v32
    v_add_u32 v33, s9, v33
    v_add_u32 v34, s10, v34
    v_add_u32 v35, 0x800, v35
    v_and_or_b32 v32, v32, v31, s4
    v_and_or_b32 v33, v33, v31, s5
    v_and_or_b32 v34, v34, v31, s6
    v_and_or_b32 v35, v35, v31, v52
    buffer_store_dwordx4 v[32:35], v24, s[36:39], s44 offen sc1
    s_mov_b64 exec, 1
    ds_add_u32 v26, v27
    s_mov_b64 exec, -1
L_done:
    s_endpgm
.section .rodata,"a"
.p2align 6
.amdhsa_kernel concat_heads__gqa_block_cached__mha_block_cached__decode_kernel
  .amdhsa_next_free_vgpr 448
  .amdhsa_next_free_sgpr 100
  .amdhsa_accum_offset 256
  .amdhsa_float_denorm_mode_32 0
  .amdhsa_group_segment_fixed_size 0
  .amdhsa_kernarg_size 104
  .amdhsa_user_sgpr_count 2
  .amdhsa_user_sgpr_kernarg_segment_ptr 1
  .amdhsa_system_sgpr_workgroup_id_x 1
.end_amdhsa_kernel
```
